```python
import torch

def _softmax(x, axis=-1):
    return torch.softmax(x, dim=axis)
def _gelu(x):
    return torch.nn.functional.gelu(x, approximate="tanh")
def _silu(x):
    return torch.nn.functional.silu(x)
def _sigmoid(x):
    return torch.sigmoid(x)
def _layernorm(x, axis=-1, eps=1e-5):
    m = x.mean(dim=axis, keepdim=True)
    v = x.var(dim=axis, keepdim=True, unbiased=False)
    return (x - m) / torch.sqrt(v + eps)
def _scatter_add(tgt, idx, src, axis=0):
    return tgt.clone().index_add_(axis, idx, src)
def _segment_sum(src, seg, n):
    out = torch.zeros((n,) + src.shape[1:], dtype=src.dtype)
    return out.index_add_(0, seg, src)
def _pad(x, pw):
    flat = tuple(v for pair in reversed(pw) for v in pair)
    return torch.nn.functional.pad(x, flat)

kernel_name = 'sequential_preLN__compressed_kv_cla__dense_activation_relu__decode'

def setup_inputs():

    _w = (lambda a: (lambda t: t.to(torch.bfloat16) if t.is_floating_point() else t)(torch.as_tensor(a)))
    def _A_setup():
        B, H, Sq, Sk, D, M = 1, 32, 1, 8192, 128, 640
        Dc = 4 * D
        return {
            "x": _w((lambda *s: torch.randn(*s, dtype=torch.bfloat16) * 0.05)(B, Sq, M)),
            "c_kv": _w((lambda *s: torch.randn(*s, dtype=torch.bfloat16) * 0.4)(B, Sk, Dc)),
            "w_q": _w((lambda *s: torch.randn(*s, dtype=torch.bfloat16) * 3.2)(M, H, D) * (M ** -0.5)),
            "w_uk": _w((lambda *s: torch.randn(*s, dtype=torch.bfloat16) * 3.2)(Dc, H, D) * (Dc ** -0.5)),
            "w_uv": _w((lambda *s: torch.randn(*s, dtype=torch.bfloat16) * 0.4)(Dc, H, D) * (Dc ** -0.5)),
            "w_o": _w((lambda *s: torch.randn(*s, dtype=torch.bfloat16) * 0.4)(H, D, M) * ((H * D) ** -0.5)),
        }
    _A_in = _A_setup()

    def _B_setup():
        B, S, D, Dff = 1, 1, 640, 1728
        return {
            "x": _w((lambda *s: torch.randn(*s, dtype=torch.bfloat16) * 0.05)(B, S, D)),
            "w1": _w((lambda *s: torch.randn(*s, dtype=torch.bfloat16) * 0.05)(D, Dff)),
            "w2": _w((lambda *s: torch.randn(*s, dtype=torch.bfloat16) * 0.05)(Dff, D)),
        }
    _B_in = _B_setup()

    return {
        "A_x": _A_in["x"],
        "A_c_kv": _A_in["c_kv"],
        "A_w_q": _A_in["w_q"],
        "A_w_uk": _A_in["w_uk"],
        "A_w_uv": _A_in["w_uv"],
        "A_w_o": _A_in["w_o"],
        "B_x": _B_in["x"],
        "B_w1": _B_in["w1"],
        "B_w2": _B_in["w2"],
    }

def reference(A_x, A_c_kv, A_w_q, A_w_uk, A_w_uv, A_w_o, B_x, B_w1, B_w2):
    def _A_ref(x, c_kv, w_q, w_uk, w_uv, w_o):
        B, Sq, M = x.shape[0], x.shape[1], x.shape[2]
        Sk = c_kv.shape[1]
        H, D = w_q.shape[1], w_q.shape[2]
        q = torch.einsum("bqm,mhd->bhqd", x, w_q)
        k = torch.einsum("bkc,chd->bhkd", c_kv, w_uk)
        v = torch.einsum("bkc,chd->bhkd", c_kv, w_uv)
        scores = torch.einsum("bhqd,bhkd->bhqk", q, k) * (D ** -0.5)
        off = Sk - Sq
        qi = torch.arange(Sq)[:, None]
        kj = torch.arange(Sk)[None, :]
        cmask = kj <= (qi + off)
        scores = torch.where(cmask[None, None], scores, -1e9)
        p = _softmax(scores, axis=-1)
        ctx = torch.einsum("bhqk,bhkd->bhqd", p, v)
        return torch.einsum("bhqd,hdm->bqm", ctx, w_o)

    def _B_ref(x, w1, w2):
        h = torch.einsum("bsd,df->bsf", x, w1)
        zero = torch.zeros_like(h)
        h = torch.maximum(h, zero)
        return torch.einsum("bsf,fd->bsd", h, w2)

    x = A_x
    h = x + _A_ref(_layernorm(x, axis=-1), A_c_kv, A_w_q, A_w_uk, A_w_uv, A_w_o)
    h2 = h + _B_ref(_layernorm(h, axis=-1), B_w1, B_w2)
    return h2
```

```asm
; @launch grid=(256,1,1) block=(512,1,1) lds=146432
.amdgcn_target "amdgcn-amd-amdhsa--gfx950"
.text
.globl sequential_preLN__compressed_kv_cla__dense_activation_relu__decode_kernel
.p2align 8
.type sequential_preLN__compressed_kv_cla__dense_activation_relu__decode_kernel,@function
sequential_preLN__compressed_kv_cla__dense_activation_relu__decode_kernel:
  s_load_dwordx16 s[16:31], s[0:1], 0
  s_load_dwordx8 s[32:39], s[0:1], 64
  s_memrealtime s[62:63]
  s_cmp_ge_u32 s2, 256
  s_cbranch_scc1 L_end
  s_cmp_ge_u32 s2, 16
  s_cbranch_scc1 L_nocp
  s_getpc_b64 s[60:61]
  v_lshlrev_b32 v6, 6, v0
  v_min_u32 v6, (L_codeend-L_nocp-64), v6
  global_load_dword v255, v6, s[60:61]
  L_nocp:
  s_and_b32 s8, s2, 7
  s_lshr_b32 s9, s2, 3
  s_and_b32 s4, s2, 127
  v_lshrrev_b32 v1, 6, v0
  v_and_b32 v2, 15, v0
  v_readfirstlane_b32 s7, v1
  v_and_b32 v1, 63, v0
  v_bfe_u32 v3, v0, 4, 2
  v_lshlrev_b32 v4, 2, v1
  v_lshlrev_b32 v5, 4, v1
  s_and_b32 s10, s9, 3
  s_lshl_b32 s5, s8, 2
  s_add_u32 s5, s5, s10
  s_lshr_b32 s6, s9, 2
  v_mov_b32 v11, 0
  s_or_b32 s10, s2, s7
  s_cmp_lg_u32 s10, 0
  s_cbranch_scc1 L_nomaster
  s_waitcnt lgkmcnt(0)
  s_mov_b32 s63, s62
  s_mul_i32 s62, s62, 0x9e3779b1
  s_or_b32 s62, s62, 1
  v_mov_b32 v16, s62
  v_mov_b32 v17, s63
  v_lshlrev_b32 v18, 6, v1
  s_mov_b64 exec, 15
  global_store_dwordx2 v18, v[16:17], s[36:37] sc1
  s_mov_b64 exec, -1
  L_nomaster:
  s_cmp_ge_u32 s7, 4
  s_cbranch_scc1 L_hi
  s_mul_i32 s10, s6, 80
  s_mul_i32 s11, s7, 20
  s_add_u32 s10, s10, s11
  s_lshl_b32 s11, s10, 13
  s_lshl_b32 s12, s5, 8
  s_add_u32 s11, s11, s12
  v_lshlrev_b32 v6, 13, v3
  v_lshl_add_u32 v6, v2, 4, v6
  v_add_u32 v6, s11, v6
  s_waitcnt lgkmcnt(0)
  global_load_dword v76, v4, s[16:17] offset:0
  global_load_dword v77, v4, s[16:17] offset:256
  global_load_dword v78, v4, s[16:17] offset:512
  global_load_dword v79, v4, s[16:17] offset:768
  global_load_dword v80, v4, s[16:17] offset:1024
  global_load_dwordx4 v[16:19], v6, s[20:21]
  v_add_u32 v6, 0x8000, v6
  global_load_dwordx4 v[20:23], v6, s[20:21]
  v_add_u32 v6, 0x8000, v6
  global_load_dwordx4 v[24:27], v6, s[20:21]
  v_add_u32 v6, 0x8000, v6
  global_load_dwordx4 v[28:31], v6, s[20:21]
  v_add_u32 v6, 0x8000, v6
  global_load_dwordx4 v[32:35], v6, s[20:21]
  s_mov_b32 s40, s38
  s_and_b32 s41, s39, 0xffff
  s_mov_b32 s42, 4227072
  s_mov_b32 s43, 0x00020000
  s_mov_b32 s56, s36
  s_and_b32 s57, s37, 0xffff
  s_mov_b32 s58, 256
  s_mov_b32 s59, 0x00020000
  v_and_b32 v92, 1, v2
  v_cmp_eq_u32 vcc, 1, v92
  v_mov_b32 v92, 0x0000ffff
  v_mov_b32 v93, 0xffff0000
  v_cndmask_b32 v92, v92, v93, vcc
  v_lshrrev_b32 v93, 1, v2
  v_cmp_eq_u32 vcc, 0, v93
  s_nop 1
  v_cndmask_b32 v68, 0, v92, vcc
  v_cmp_eq_u32 vcc, 1, v93
  s_nop 1
  v_cndmask_b32 v69, 0, v92, vcc
  v_cmp_eq_u32 vcc, 2, v93
  s_nop 1
  v_cndmask_b32 v70, 0, v92, vcc
  v_cmp_eq_u32 vcc, 3, v93
  s_nop 1
  v_cndmask_b32 v71, 0, v92, vcc
  s_mul_i32 s14, s7, 2560
  s_add_u32 s14, s14, 133248
  v_lshlrev_b32 v8, 3, v1
  v_add_u32 v8, s14, v8
  s_lshl_b32 s15, s10, 2
  s_add_u32 s15, s15, s14
  v_lshl_add_u32 v9, v3, 2, s15
  v_lshlrev_b32 v10, 5, v2
  v_lshl_add_u32 v10, v3, 4, v10
  s_lshl_b32 s14, s7, 9
  s_add_u32 s14, s14, 143488
  v_add_u32 v10, s14, v10
  v_mov_b32 v227, 133120
  v_add_u32 v7, 143488, v5
  s_lshl_b32 s68, s5, 12
  s_add_u32 s68, s68, 0
  s_lshl_b32 s69, s6, 9
  s_add_u32 s69, s69, s68
  s_waitcnt vmcnt(5)
  v_lshlrev_b32 v82, 16, v76
  v_and_b32 v83, 0xffff0000, v76
  v_lshlrev_b32 v84, 16, v77
  v_and_b32 v85, 0xffff0000, v77
  v_lshlrev_b32 v86, 16, v78
  v_and_b32 v87, 0xffff0000, v78
  v_lshlrev_b32 v88, 16, v79
  v_and_b32 v89, 0xffff0000, v79
  v_lshlrev_b32 v90, 16, v80
  v_and_b32 v91, 0xffff0000, v80
  s_nop 0
  v_readfirstlane_b32 s62, v82
  s_nop 1
  v_mov_b32 v96, s62
  v_pk_add_f32 v[250:251], v[82:83], v[96:97] op_sel_hi:[1,0] neg_lo:[0,1] neg_hi:[0,1]
  v_pk_mul_f32 v[94:95], v[250:251], v[250:251]
  v_mov_b32 v92, v250
  v_mov_b32 v93, v251
  v_pk_add_f32 v[250:251], v[84:85], v[96:97] op_sel_hi:[1,0] neg_lo:[0,1] neg_hi:[0,1]
  v_pk_fma_f32 v[94:95], v[250:251], v[250:251], v[94:95]
  v_pk_add_f32 v[92:93], v[92:93], v[250:251]
  v_pk_add_f32 v[250:251], v[86:87], v[96:97] op_sel_hi:[1,0] neg_lo:[0,1] neg_hi:[0,1]
  v_pk_fma_f32 v[94:95], v[250:251], v[250:251], v[94:95]
  v_pk_add_f32 v[92:93], v[92:93], v[250:251]
  v_pk_add_f32 v[250:251], v[88:89], v[96:97] op_sel_hi:[1,0] neg_lo:[0,1] neg_hi:[0,1]
  v_pk_fma_f32 v[94:95], v[250:251], v[250:251], v[94:95]
  v_pk_add_f32 v[92:93], v[92:93], v[250:251]
  v_pk_add_f32 v[250:251], v[90:91], v[96:97] op_sel_hi:[1,0] neg_lo:[0,1] neg_hi:[0,1]
  v_pk_fma_f32 v[94:95], v[250:251], v[250:251], v[94:95]
  v_pk_add_f32 v[92:93], v[92:93], v[250:251]
  v_add_f32 v94, v94, v95
  v_add_f32 v92, v92, v93
  v_mov_b32 v97, 0x3acccccd
  v_add_f32_dpp v94, v94, v94 row_shr:1 row_mask:0xf bank_mask:0xf bound_ctrl:0
  v_add_f32_dpp v92, v92, v92 row_shr:1 row_mask:0xf bank_mask:0xf bound_ctrl:0
  s_nop 0
  v_add_f32_dpp v94, v94, v94 row_shr:2 row_mask:0xf bank_mask:0xf bound_ctrl:0
  v_add_f32_dpp v92, v92, v92 row_shr:2 row_mask:0xf bank_mask:0xf bound_ctrl:0
  s_nop 0
  v_add_f32_dpp v94, v94, v94 row_shr:4 row_mask:0xf bank_mask:0xf bound_ctrl:0
  v_add_f32_dpp v92, v92, v92 row_shr:4 row_mask:0xf bank_mask:0xf bound_ctrl:0
  s_nop 0
  v_add_f32_dpp v94, v94, v94 row_shr:8 row_mask:0xf bank_mask:0xf bound_ctrl:0
  v_add_f32_dpp v92, v92, v92 row_shr:8 row_mask:0xf bank_mask:0xf bound_ctrl:0
  s_nop 0
  v_add_f32_dpp v94, v94, v94 row_bcast:15 row_mask:0xa bank_mask:0xf
  v_add_f32_dpp v92, v92, v92 row_bcast:15 row_mask:0xa bank_mask:0xf
  s_nop 0
  v_add_f32_dpp v94, v94, v94 row_bcast:31 row_mask:0xc bank_mask:0xf
  v_add_f32_dpp v92, v92, v92 row_bcast:31 row_mask:0xc bank_mask:0xf
  s_nop 0
  v_readlane_b32 s63, v94, 63
  v_readlane_b32 s62, v92, 63
  s_nop 0
  v_mul_f32 v94, s63, v97
  v_mul_f32 v92, s62, v97
  v_fma_f32 v94, -v92, v92, v94
  v_add_f32 v96, v96, v92
  v_max_f32 v94, 0, v94
  v_cvt_pk_bf16_f32 v95, v96, v94
  v_lshlrev_b32 v96, 16, v95
  v_and_b32 v94, 0xffff0000, v95
  v_add_f32 v94, 0x3727c5ac, v94
  v_cvt_pk_bf16_f32 v94, v94, v94
  v_and_b32 v94, 0xffff0000, v94
  v_sqrt_f32 v94, v94
  v_pk_add_f32 v[82:83], v[82:83], v[96:97] op_sel_hi:[1,0] neg_lo:[0,1] neg_hi:[0,1]
  v_pk_add_f32 v[84:85], v[84:85], v[96:97] op_sel_hi:[1,0] neg_lo:[0,1] neg_hi:[0,1]
  v_pk_add_f32 v[86:87], v[86:87], v[96:97] op_sel_hi:[1,0] neg_lo:[0,1] neg_hi:[0,1]
  v_pk_add_f32 v[88:89], v[88:89], v[96:97] op_sel_hi:[1,0] neg_lo:[0,1] neg_hi:[0,1]
  v_pk_add_f32 v[90:91], v[90:91], v[96:97] op_sel_hi:[1,0] neg_lo:[0,1] neg_hi:[0,1]
  v_cvt_pk_bf16_f32 v94, v94, v94
  v_and_b32 v94, 0xffff0000, v94
  v_rcp_f32 v94, v94
  v_cvt_pk_bf16_f32 v92, v82, v83
  v_lshlrev_b32 v82, 16, v92
  v_and_b32 v83, 0xffff0000, v92
  v_pk_mul_f32 v[82:83], v[82:83], v[94:95] op_sel_hi:[1,0]
  v_cvt_pk_bf16_f32 v92, v84, v85
  v_lshlrev_b32 v84, 16, v92
  v_and_b32 v85, 0xffff0000, v92
  v_pk_mul_f32 v[84:85], v[84:85], v[94:95] op_sel_hi:[1,0]
  v_cvt_pk_bf16_f32 v92, v86, v87
  v_lshlrev_b32 v86, 16, v92
  v_and_b32 v87, 0xffff0000, v92
  v_pk_mul_f32 v[86:87], v[86:87], v[94:95] op_sel_hi:[1,0]
  v_cvt_pk_bf16_f32 v92, v88, v89
  v_lshlrev_b32 v88, 16, v92
  v_and_b32 v89, 0xffff0000, v92
  v_pk_mul_f32 v[88:89], v[88:89], v[94:95] op_sel_hi:[1,0]
  v_cvt_pk_bf16_f32 v92, v90, v91
  v_lshlrev_b32 v90, 16, v92
  v_and_b32 v91, 0xffff0000, v92
  v_pk_mul_f32 v[90:91], v[90:91], v[94:95] op_sel_hi:[1,0]
  v_cvt_pk_bf16_f32 v92, v82, v82
  v_cvt_pk_bf16_f32 v93, v83, v83
  ds_write_b64 v8, v[92:93] offset:0
  v_cvt_pk_bf16_f32 v94, v84, v84
  v_cvt_pk_bf16_f32 v95, v85, v85
  ds_write_b64 v8, v[94:95] offset:512
  v_cvt_pk_bf16_f32 v92, v86, v86
  v_cvt_pk_bf16_f32 v93, v87, v87
  ds_write_b64 v8, v[92:93] offset:1024
  v_cvt_pk_bf16_f32 v94, v88, v88
  v_cvt_pk_bf16_f32 v95, v89, v89
  ds_write_b64 v8, v[94:95] offset:1536
  v_cvt_pk_bf16_f32 v92, v90, v90
  v_cvt_pk_bf16_f32 v93, v91, v91
  ds_write_b64 v8, v[92:93] offset:2048
  s_waitcnt lgkmcnt(0)
  ds_read_b32 v82, v9 offset:0
  ds_read_b32 v83, v9 offset:16
  ds_read_b32 v84, v9 offset:32
  ds_read_b32 v85, v9 offset:48
  ds_read_b32 v86, v9 offset:64
  s_waitcnt lgkmcnt(0)
  v_and_b32 v96, v82, v68
  v_and_b32 v97, v82, v69
  v_and_b32 v98, v82, v70
  v_and_b32 v99, v82, v71
  v_and_b32 v100, v83, v68
  v_and_b32 v101, v83, v69
  v_and_b32 v102, v83, v70
  v_and_b32 v103, v83, v71
  v_and_b32 v104, v84, v68
  v_and_b32 v105, v84, v69
  v_and_b32 v106, v84, v70
  v_and_b32 v107, v84, v71
  v_and_b32 v108, v85, v68
  v_and_b32 v109, v85, v69
  v_and_b32 v110, v85, v70
  v_and_b32 v111, v85, v71
  v_and_b32 v112, v86, v68
  v_and_b32 v113, v86, v69
  v_and_b32 v114, v86, v70
  v_and_b32 v115, v86, v71
  s_cmp_lg_u32 s7, 0
  s_cbranch_scc1 L_a_nn_1
  s_load_dwordx2 s[28:29], s[36:37], 0
  s_waitcnt lgkmcnt(0)
  s_mov_b32 s65, s28
  s_cmp_lg_u32 s65, 0
  s_cbranch_scc1 L_nnd_2
  s_sleep 4
  s_load_dwordx2 s[28:29], s[36:37], 64
  s_waitcnt lgkmcnt(0)
  s_mov_b32 s65, s28
  s_cmp_lg_u32 s65, 0
  s_cbranch_scc1 L_nnd_2
  s_sleep 4
  s_load_dwordx2 s[28:29], s[36:37], 128
  s_waitcnt lgkmcnt(0)
  s_mov_b32 s65, s28
  s_cmp_lg_u32 s65, 0
  s_cbranch_scc1 L_nnd_2
  s_sleep 4
  s_load_dwordx2 s[28:29], s[36:37], 192
  s_waitcnt lgkmcnt(0)
  s_mov_b32 s65, s28
  s_cmp_lg_u32 s65, 0
  s_cbranch_scc1 L_nnd_2
  s_sleep 4
  s_mov_b32 s60, 0
L_nn_3:
  buffer_load_dword v90, v11, s[56:59], 0 offen sc1
  s_add_u32 s60, s60, 1
  s_waitcnt vmcnt(0)
  v_readfirstlane_b32 s65, v90
  s_cmp_ge_u32 s60, 100000
  s_cbranch_scc1 L_nnd_2
  s_cmp_eq_u32 s65, 0
  s_cbranch_scc1 L_nn_3
L_nnd_2:
  v_mov_b32 v90, s65
  v_mov_b32 v91, s29
  ds_write_b64 v227, v[90:91] offset:0
L_a_nn_1:
  s_waitcnt vmcnt(4)
  v_mfma_f32_16x16x32_bf16 v[116:119], v[96:99], v[16:19], 0
  s_waitcnt vmcnt(3)
  v_mfma_f32_16x16x32_bf16 v[116:119], v[100:103], v[20:23], v[116:119]
  s_waitcnt vmcnt(2)
  v_mfma_f32_16x16x32_bf16 v[116:119], v[104:107], v[24:27], v[116:119]
  s_waitcnt vmcnt(1)
  v_mfma_f32_16x16x32_bf16 v[116:119], v[108:111], v[28:31], v[116:119]
  s_waitcnt vmcnt(0)
  v_mfma_f32_16x16x32_bf16 v[116:119], v[112:115], v[32:35], v[116:119]
  s_nop 2
  s_nop 4
  s_mov_b32 exec_hi, 0
  ds_write_b128 v10, v[116:119]
  s_mov_b64 exec, -1
  s_waitcnt lgkmcnt(0)
  s_barrier
  s_cmp_lg_u32 s7, 0
  s_cbranch_scc1 L_lo123
  ds_read_b128 v[120:123], v7 offset:0
  ds_read_b128 v[124:127], v7 offset:512
  ds_read_b128 v[128:131], v7 offset:1024
  ds_read_b128 v[132:135], v7 offset:1536
  s_mov_b32 s64, 0xffffff00
  s_and_b32 s61, s65, 0xff
  v_mov_b32 v12, s61
  s_bfe_u32 s61, s65, 0x80008
  v_mov_b32 v13, s61
  s_bfe_u32 s61, s65, 0x80010
  v_mov_b32 v14, s61
  s_lshr_b32 s61, s65, 24
  v_mov_b32 v15, s61
  s_and_b32 s67, s65, 0xbfffbfff
  s_waitcnt lgkmcnt(0)
  v_pk_add_f32 v[120:121], v[120:121], v[124:125]
  v_pk_add_f32 v[122:123], v[122:123], v[126:127]
  v_pk_add_f32 v[128:129], v[128:129], v[132:133]
  v_pk_add_f32 v[130:131], v[130:131], v[134:135]
  v_pk_add_f32 v[120:121], v[120:121], v[128:129]
  v_pk_add_f32 v[122:123], v[122:123], v[130:131]
  v_and_or_b32 v120, v120, s64, v12
  v_and_or_b32 v121, v121, s64, v13
  v_and_or_b32 v122, v122, s64, v14
  v_and_or_b32 v123, v123, s64, v15
  s_mov_b32 exec_hi, 0
  buffer_store_dwordx4 v[120:123], v5, s[40:43], s69 offen
  s_mov_b64 exec, -1
  s_mov_b32 s73, s69
  s_cmp_ge_u32 s9, 16
  s_cbranch_scc1 L_kv_w0
  v_and_b32 v8, 31, v1
  v_lshlrev_b32 v8, 3, v8
  v_lshrrev_b32 v9, 5, v1
  v_lshl_add_u32 v8, v9, 2, v8
  s_mov_b32 s60, 0
L_pl_4:
  buffer_load_dwordx4 v[124:127], v5, s[40:43], s68 offen offset:0 sc1
  buffer_load_dwordx4 v[128:131], v5, s[40:43], s68 offen offset:1024 sc1
  buffer_load_dwordx4 v[132:135], v5, s[40:43], s68 offen offset:2048 sc1
  buffer_load_dwordx4 v[136:139], v5, s[40:43], s68 offen offset:3072 sc1
  s_add_u32 s60, s60, 1
  s_cmp_lg_u32 s60, 10
  s_cbranch_scc1 L_pnr_6
  s_mov_b32 exec_hi, 0
  buffer_store_dwordx4 v[120:123], v5, s[40:43], s73 offen sc1
  s_mov_b64 exec, -1
L_pnr_6:
  s_cmp_ge_u32 s60, 100000
  s_cbranch_scc1 L_pld_5
  s_waitcnt vmcnt(0)
  v_xor_b32 v90, v124, v12
  v_bitop3_b32 v90, v90, v125, v13 bitop3:0xf6
  v_bitop3_b32 v90, v90, v126, v14 bitop3:0xf6
  v_bitop3_b32 v90, v90, v127, v15 bitop3:0xf6
  v_bitop3_b32 v90, v90, v128, v12 bitop3:0xf6
  v_bitop3_b32 v90, v90, v129, v13 bitop3:0xf6
  v_bitop3_b32 v90, v90, v130, v14 bitop3:0xf6
  v_bitop3_b32 v90, v90, v131, v15 bitop3:0xf6
  v_bitop3_b32 v90, v90, v132, v12 bitop3:0xf6
  v_bitop3_b32 v90, v90, v133, v13 bitop3:0xf6
  v_bitop3_b32 v90, v90, v134, v14 bitop3:0xf6
  v_bitop3_b32 v90, v90, v135, v15 bitop3:0xf6
  v_bitop3_b32 v90, v90, v136, v12 bitop3:0xf6
  v_bitop3_b32 v90, v90, v137, v13 bitop3:0xf6
  v_bitop3_b32 v90, v90, v138, v14 bitop3:0xf6
  v_bitop3_b32 v90, v90, v139, v15 bitop3:0xf6
  v_and_b32 v90, 0xff, v90
  v_cmp_ne_u32 vcc, 0, v90
  s_cmp_lg_u64 vcc, 0
  s_cbranch_scc1 L_pl_4
L_pld_5:
  s_waitcnt vmcnt(0)
  v_pk_add_f32 v[124:125], v[124:125], v[128:129]
  v_pk_add_f32 v[126:127], v[126:127], v[130:131]
  v_pk_add_f32 v[132:133], v[132:133], v[136:137]
  v_pk_add_f32 v[134:135], v[134:135], v[138:139]
  v_pk_add_f32 v[124:125], v[124:125], v[132:133]
  v_pk_add_f32 v[126:127], v[126:127], v[134:135]
  s_nop 0
  v_permlane32_swap_b32 v124, v126
  v_permlane32_swap_b32 v125, v127
  s_nop 0
  v_pk_add_f32 v[124:125], v[124:125], v[126:127]
  v_cvt_pk_bf16_f32 v124, v124, v125
  ds_write_b32 v8, v124 offset:24576
  ds_write_b32 v11, v11 offset:25100
  ds_write_b32 v11, v11 offset:25116
  s_waitcnt lgkmcnt(0)
  s_barrier
  v_lshrrev_b32 v8, 1, v1
  v_and_b32 v9, 1, v1
  v_cmp_gt_u32 vcc, 8, v8
  v_lshlrev_b32 v128, 4, v8
  v_mul_u32_u24 v129, 48, v8
  v_add_u32 v129, 0xfffffe8c, v129
  v_cndmask_b32 v128, v129, v128, vcc
  v_lshl_add_u32 v128, v9, 7, v128
  v_mov_b32 v129, 16
  v_cndmask_b32 v130, v129, 4, vcc
  v_add_u32 v129, v128, v130
  v_add_u32 v130, v129, v130
  v_mov_b32 v8, v5
  s_lshl_b32 s10, s6, 5
  s_add_u32 s10, s10, s5
  s_mul_i32 s10, s10, 352
  s_add_u32 s10, s10, 131072
  v_mov_b32 v127, s67
  v_mov_b32 v90, s65
  s_lshl_b32 s70, s4, 7
  s_add_u32 s70, s70, 3538944
  s_memrealtime s[0:1]
  s_waitcnt lgkmcnt(0)
  v_mov_b32 v91, s0
  buffer_store_dwordx2 v[90:91], v11, s[40:43], s70 offen sc1
  s_mov_b32 exec_lo, 0x3fffff
  s_mov_b32 exec_hi, 0
  s_barrier
  ds_read_b32 v124, v128 offset:24832
  ds_read_b32 v125, v129 offset:24832
  ds_read_b32 v126, v130 offset:24832
  s_waitcnt lgkmcnt(0)
  buffer_store_dwordx4 v[124:127], v8, s[40:43], s10 offen sc1
  s_mov_b64 exec, -1
  s_branch L_w_join
L_lo123:
  s_cmp_ge_u32 s9, 16
  s_cbranch_scc1 L_kv_lo
  ds_read_b32 v90, v227 offset:0
  s_waitcnt lgkmcnt(0)
  v_readfirstlane_b32 s65, v90
  s_mov_b32 s64, 0xffffff00
  s_and_b32 s61, s65, 0xff
  v_mov_b32 v12, s61
  s_bfe_u32 s61, s65, 0x80008
  v_mov_b32 v13, s61
  s_bfe_u32 s61, s65, 0x80010
  v_mov_b32 v14, s61
  s_lshr_b32 s61, s65, 24
  v_mov_b32 v15, s61
  s_and_b32 s67, s65, 0xbfffbfff
  s_barrier
  s_barrier
  s_branch L_w_join
L_hi:
  s_lshr_b32 s13, s6, 1
  s_lshl_b32 s13, s13, 6
  s_and_b32 s14, s6, 1
  s_lshl_b32 s14, s14, 8
  s_add_u32 s13, s13, s14
  s_bfe_u32 s14, s7, 0x10001
  s_lshl_b32 s14, s14, 7
  s_add_u32 s13, s13, s14
  s_and_b32 s14, s7, 1
  s_lshl_b32 s14, s14, 5
  s_add_u32 s13, s13, s14
  s_lshl_b32 s13, s13, 13
  s_lshl_b32 s12, s5, 8
  s_add_u32 s13, s13, s12
  v_xor_b32 v7, v2, v3
  v_lshlrev_b32 v7, 4, v7
  v_lshl_add_u32 v7, v3, 13, v7
  v_mov_b32 v227, 133120
  s_waitcnt lgkmcnt(0)
  s_mov_b32 s56, s36
  s_and_b32 s57, s37, 0xffff
  s_mov_b32 s58, 256
  s_mov_b32 s59, 0x00020000
  s_mov_b32 s40, s38
  s_and_b32 s41, s39, 0xffff
  s_mov_b32 s42, 4227072
  s_mov_b32 s43, 0x00020000
  s_cmp_ge_u32 s9, 16
  s_cbranch_scc1 L_kv_hi
  s_cmp_lg_u32 s7, 4
  s_cbranch_scc1 L_w_pw_7
  s_lshl_b32 s68, s5, 12
  s_add_u32 s68, s68, 0
  v_lshlrev_b32 v8, 6, v1
  buffer_load_dword v91, v8, s[40:43], s68 offen sc1
L_w_pw_7:
  s_sleep 1
  s_mov_b32 s52, s22
  s_and_b32 s53, s23, 0xffff
  s_mov_b32 s54, 4194304
  s_mov_b32 s55, 0x00020000
  s_sub_u32 s14, s7, 4
  s_lshl_b32 s14, s14, 13
  s_add_u32 s14, s14, 32768
  v_lshlrev_b32 v6, 8, v2
  v_add_u32 v6, s14, v6
  s_mov_b32 m0, s14
  v_xor_b32 v8, 0, v7
  buffer_load_dwordx4 v8, s[52:55], s13 offen  lds
  s_add_u32 s14, s14, 1024
  s_add_u32 s13, s13, 32768
  s_mov_b32 m0, s14
  v_xor_b32 v8, 64, v7
  buffer_load_dwordx4 v8, s[52:55], s13 offen  lds
  s_add_u32 s14, s14, 1024
  s_add_u32 s13, s13, 32768
  s_mov_b32 m0, s14
  v_xor_b32 v8, 128, v7
  buffer_load_dwordx4 v8, s[52:55], s13 offen  lds
  s_add_u32 s14, s14, 1024
  s_add_u32 s13, s13, 32768
  s_mov_b32 m0, s14
  v_xor_b32 v8, 192, v7
  buffer_load_dwordx4 v8, s[52:55], s13 offen  lds
  s_add_u32 s14, s14, 1024
  s_add_u32 s13, s13, 32768
  s_mov_b32 m0, s14
  v_xor_b32 v8, 0, v7
  buffer_load_dwordx4 v8, s[52:55], s13 offen  lds
  s_add_u32 s14, s14, 1024
  s_add_u32 s13, s13, 32768
  s_mov_b32 m0, s14
  v_xor_b32 v8, 64, v7
  buffer_load_dwordx4 v8, s[52:55], s13 offen  lds
  s_add_u32 s14, s14, 1024
  s_add_u32 s13, s13, 32768
  s_mov_b32 m0, s14
  v_xor_b32 v8, 128, v7
  buffer_load_dwordx4 v8, s[52:55], s13 offen  lds
  s_add_u32 s14, s14, 1024
  s_add_u32 s13, s13, 32768
  s_mov_b32 m0, s14
  v_xor_b32 v8, 192, v7
  buffer_load_dwordx4 v8, s[52:55], s13 offen  lds
  s_add_u32 s14, s14, 1024
  s_add_u32 s13, s13, 32768
  v_or_b32 v8, 0, v3
  v_xor_b32 v8, v8, v2
  v_lshl_add_u32 v100, v8, 4, v6
  v_or_b32 v8, 4, v3
  v_xor_b32 v8, v8, v2
  v_lshl_add_u32 v101, v8, 4, v6
  v_or_b32 v8, 8, v3
  v_xor_b32 v8, v8, v2
  v_lshl_add_u32 v102, v8, 4, v6
  v_or_b32 v8, 12, v3
  v_xor_b32 v8, v8, v2
  v_lshl_add_u32 v103, v8, 4, v6
  v_lshlrev_b32 v9, 4, v3
  s_sub_u32 s14, s7, 4
  s_lshl_b32 s14, s14, 6
  v_lshl_add_u32 v8, v3, 3, s14
  s_barrier
  ds_read_b32 v90, v227 offset:0
  s_waitcnt lgkmcnt(0)
  v_readfirstlane_b32 s65, v90
  s_mov_b32 s64, 0xffffff00
  s_and_b32 s61, s65, 0xff
  v_mov_b32 v12, s61
  s_bfe_u32 s61, s65, 0x80008
  v_mov_b32 v13, s61
  s_bfe_u32 s61, s65, 0x80010
  v_mov_b32 v14, s61
  s_lshr_b32 s61, s65, 24
  v_mov_b32 v15, s61
  s_and_b32 s67, s65, 0xbfffbfff
  s_waitcnt vmcnt(0)
  ds_read_b128 v[36:39], v100
  ds_read_b128 v[52:55], v100 offset:4096
  ds_read_b128 v[40:43], v101
  ds_read_b128 v[56:59], v101 offset:4096
  ds_read_b128 v[44:47], v102
  ds_read_b128 v[60:63], v102 offset:4096
  ds_read_b128 v[48:51], v103
  ds_read_b128 v[64:67], v103 offset:4096
  s_waitcnt lgkmcnt(0)
  s_barrier
  ds_read_b128 v[120:123], v9 offset:24576
  ds_read_b128 v[124:127], v9 offset:24640
  ds_read_b128 v[128:131], v9 offset:24704
  ds_read_b128 v[132:135], v9 offset:24768
  s_waitcnt lgkmcnt(3)
  v_mfma_f32_16x16x32_bf16 v[116:119], v[36:39], v[120:123], 0
  v_mfma_f32_16x16x32_bf16 v[136:139], v[52:55], v[120:123], 0
  s_waitcnt lgkmcnt(2)
  v_mfma_f32_16x16x32_bf16 v[116:119], v[40:43], v[124:127], v[116:119]
  v_mfma_f32_16x16x32_bf16 v[136:139], v[56:59], v[124:127], v[136:139]
  s_waitcnt lgkmcnt(1)
  v_mfma_f32_16x16x32_bf16 v[116:119], v[44:47], v[128:131], v[116:119]
  v_mfma_f32_16x16x32_bf16 v[136:139], v[60:63], v[128:131], v[136:139]
  s_waitcnt lgkmcnt(0)
  v_mfma_f32_16x16x32_bf16 v[116:119], v[48:51], v[132:135], v[116:119]
  v_mfma_f32_16x16x32_bf16 v[136:139], v[64:67], v[132:135], v[136:139]
  s_nop 6
  v_cvt_pk_bf16_f32 v140, v116, v117
  v_cvt_pk_bf16_f32 v141, v118, v119
  v_cvt_pk_bf16_f32 v142, v136, v137
  v_cvt_pk_bf16_f32 v143, v138, v139
  ds_write_b64 v8, v[140:141] offset:24832
  ds_write_b64 v8, v[142:143] offset:24864
  s_waitcnt lgkmcnt(0)
  s_barrier
L_w_join:
  v_and_b32 v92, 1, v2
  v_cmp_eq_u32 vcc, 1, v92
  v_mov_b32 v92, 0x0000ffff
  v_mov_b32 v93, 0xffff0000
  v_cndmask_b32 v92, v92, v93, vcc
  v_bfe_u32 v93, v2, 1, 2
  v_cmp_eq_u32 vcc, 0, v93
  s_nop 1
  v_cndmask_b32 v72, 0, v92, vcc
  v_cmp_eq_u32 vcc, 1, v93
  s_nop 1
  v_cndmask_b32 v73, 0, v92, vcc
  v_cmp_eq_u32 vcc, 2, v93
  s_nop 1
  v_cndmask_b32 v74, 0, v92, vcc
  v_cmp_eq_u32 vcc, 3, v93
  s_nop 1
  v_cndmask_b32 v75, 0, v92, vcc
  s_lshr_b32 s10, s6, 1
  s_and_b32 s11, s6, 1
  v_lshrrev_b32 v6, 3, v2
  v_lshl_add_u32 v6, v6, 2, v3
  v_lshlrev_b32 v7, 4, v6
  v_lshlrev_b32 v6, 13, v6
  v_and_b32 v8, 7, v2
  v_lshl_add_u32 v6, v8, 4, v6
  s_lshl_b32 s12, s10, 8
  s_lshl_b32 s13, s7, 5
  s_add_u32 s12, s12, s13
  s_lshl_b32 s12, s12, 13
  s_lshl_b32 s13, s5, 8
  s_add_u32 s12, s12, s13
  s_lshl_b32 s13, s11, 7
  s_add_u32 s12, s12, s13
  v_add_u32 v6, s12, v6
  global_load_dwordx4 v[16:19], v6, s[24:25]
  v_add_u32 v6, 0x10000, v6
  global_load_dwordx4 v[20:23], v6, s[24:25]
  v_add_u32 v6, 0x10000, v6
  global_load_dwordx4 v[24:27], v6, s[24:25]
  v_add_u32 v6, 0x10000, v6
  global_load_dwordx4 v[28:31], v6, s[24:25]
  s_cmp_ge_u32 s7, 4
  s_cbranch_scc1 L_w_nowo_8
  v_mul_u32_u24 v6, 5120, v3
  v_lshl_add_u32 v6, v2, 4, v6
  s_lshl_b32 s12, s5, 7
  s_lshl_b32 s13, s11, 6
  s_add_u32 s12, s12, s13
  s_lshl_b32 s13, s7, 4
  s_add_u32 s12, s12, s13
  s_mul_i32 s12, s12, 1280
  v_add_u32 v6, s12, v6
  global_load_dwordx4 v[160:163], v6, s[26:27] offset:0
  global_load_dwordx4 v[164:167], v6, s[26:27] offset:256
  global_load_dwordx4 v[168:171], v6, s[26:27] offset:512
  global_load_dwordx4 v[172:175], v6, s[26:27] offset:768
  global_load_dwordx4 v[176:179], v6, s[26:27] offset:1024
  global_load_dwordx4 v[180:183], v6, s[26:27] offset:1280
  global_load_dwordx4 v[184:187], v6, s[26:27] offset:1536
  global_load_dwordx4 v[188:191], v6, s[26:27] offset:1792
  global_load_dwordx4 v[192:195], v6, s[26:27] offset:2048
  global_load_dwordx4 v[196:199], v6, s[26:27] offset:2304
  v_add_u32 v6, 2560, v6
  global_load_dwordx4 v[200:203], v6, s[26:27] offset:0
  global_load_dwordx4 v[204:207], v6, s[26:27] offset:256
  global_load_dwordx4 v[208:211], v6, s[26:27] offset:512
  global_load_dwordx4 v[212:215], v6, s[26:27] offset:768
  global_load_dwordx4 v[216:219], v6, s[26:27] offset:1024
  global_load_dwordx4 v[220:223], v6, s[26:27] offset:1280
  global_load_dwordx4 v[224:227], v6, s[26:27] offset:1536
  global_load_dwordx4 v[228:231], v6, s[26:27] offset:1792
  global_load_dwordx4 v[232:235], v6, s[26:27] offset:2048
  global_load_dwordx4 v[236:239], v6, s[26:27] offset:2304
  s_branch L_w_fgp_9
L_w_nowo_8:
L_w_fgp_9:
  v_and_b32 v8, 1, v3
  v_lshlrev_b32 v8, 1, v8
  v_lshrrev_b32 v9, 1, v3
  v_or_b32 v8, v8, v9
  v_and_b32 v9, 1, v1
  v_lshl_add_u32 v8, v9, 2, v8
  v_bfe_u32 v9, v1, 1, 2
  v_lshl_add_u32 v8, v8, 2, v9
  v_lshlrev_b32 v8, 2, v8
  s_lshl_b32 s12, s7, 7
  v_add_u32 v8, s12, v8
  v_add_u32 v7, s12, v7
  v_lshrrev_b32 v9, 3, v1
  v_lshlrev_b32 v10, 4, v9
  v_lshlrev_b32 v9, 9, v9
  v_and_b32 v6, 7, v1
  v_lshl_add_u32 v9, v6, 4, v9
  s_lshl_b32 s12, s5, 2
  s_lshl_b32 s13, s10, 1
  s_add_u32 s12, s12, s13
  s_lshr_b32 s13, s7, 2
  s_add_u32 s12, s12, s13
  s_lshl_b32 s12, s12, 14
  s_and_b32 s13, s7, 3
  s_lshl_b32 s13, s13, 7
  s_add_u32 s12, s12, s13
  s_add_u32 s12, s12, 786432
  s_add_u32 s13, s12, 4096
  s_add_u32 s14, s12, 8192
  s_add_u32 s15, s12, 12288
  s_lshl_b32 s68, s5, 9
  s_add_u32 s68, s68, 2883584
  v_and_b32 v36, 7, v2
  v_lshlrev_b32 v36, 5, v36
  v_lshl_add_u32 v36, v3, 4, v36
  s_lshl_b32 s61, s7, 8
  v_add_u32 v36, s61, v36
  s_lshl_b32 s61, s7, 6
  v_lshl_add_u32 v37, v3, 4, s61
  v_lshlrev_b32 v38, 5, v2
  v_lshl_add_u32 v38, v3, 4, v38
  s_mul_i32 s61, s7, 2560
  v_add_u32 v38, s61, v38
  v_subrev_u32 v39, 256, v0
  v_lshrrev_b32 v40, 3, v39
  v_lshlrev_b32 v40, 11, v40
  v_and_b32 v41, 7, v39
  v_lshl_add_u32 v40, v41, 4, v40
  v_lshlrev_b32 v41, 4, v39
  s_mul_i32 s69, s8, 40960
  s_lshl_b32 s61, s9, 7
  s_add_u32 s69, s69, s61
  s_add_u32 s69, s69, 2899968
  s_and_b32 s61, s4, 0x67
  v_mov_b32 v42, s65
  s_mov_b32 s62, 0x3fb8aa3b
  s_lshl_b32 s70, s61, 7
  s_add_u32 s70, s70, 3555328
  s_lshl_b32 s71, s4, 7
  s_add_u32 s71, s71, 3571712
  s_lshl_b32 s72, s4, 7
  s_add_u32 s72, s72, 3588096
  s_waitcnt vmcnt(0)
  s_cmp_lg_u32 s7, 0
  s_cbranch_scc1 L_w_rq_10
  s_mov_b32 exec_hi, 0
  buffer_store_dwordx4 v[120:123], v5, s[40:43], s73 offen sc1
  s_mov_b64 exec, -1
L_w_rq_10:
  s_sub_u32 s61, s7, 4
  s_lshl_b32 s61, s61, 4
  s_add_u32 s61, s61, s9
  s_cmp_ge_u32 s61, 20
  s_cbranch_scc1 L_w_pe_11
  s_mul_i32 s63, s8, 20
  s_add_u32 s63, s63, s61
  s_lshl_b32 s63, s63, 11
  s_add_u32 s63, s63, 2899968
  v_lshlrev_b32 v44, 5, v1
  buffer_load_dword v45, v44, s[40:43], s63 offen sc1
L_w_pe_11:
  s_mov_b32 s60, 0
L_sg_12:
  s_load_dwordx2 s[28:29], s[38:39], s71 glc
  s_add_u32 s60, s60, 1
  s_cmp_ge_u32 s60, 100000
  s_cbranch_scc1 L_sgd_13
  s_waitcnt lgkmcnt(0)
  s_cmp_lg_u32 s28, s65
  s_cbranch_scc1 L_sg_12
L_un_14:
  s_memrealtime s[0:1]
  s_waitcnt lgkmcnt(0)
  s_sub_u32 s0, s0, s29
  s_cmp_lt_u32 s0, 135
  s_cbranch_scc1 L_un_14
L_sgd_13:
  s_waitcnt lgkmcnt(0)
  s_mov_b32 s60, 0
L_w_h3_15:
  buffer_load_dwordx4 v[48:51], v10, s[40:43], s68 offen offset:0 sc1
  buffer_load_dwordx4 v[52:55], v10, s[40:43], s68 offen offset:128 sc1
  buffer_load_dwordx4 v[56:59], v10, s[40:43], s68 offen offset:256 sc1
  buffer_load_dwordx4 v[60:63], v10, s[40:43], s68 offen offset:384 sc1
  buffer_load_dwordx4 v[120:123], v9, s[40:43], s12 offen sc1
  buffer_load_dwordx4 v[124:127], v9, s[40:43], s13 offen sc1
  buffer_load_dwordx4 v[128:131], v9, s[40:43], s14 offen sc1
  buffer_load_dwordx4 v[132:135], v9, s[40:43], s15 offen sc1
  s_add_u32 s60, s60, 1
  s_waitcnt vmcnt(4)
  v_and_b32 v140, s64, v48
  v_and_b32 v142, s64, v52
  v_and_b32 v144, s64, v56
  v_and_b32 v146, s64, v60
  v_max3_f32 v44, v140, v142, v144
  v_max_f32 v44, v44, v146
  v_xor_b32 v47, v48, v12
  v_bitop3_b32 v47, v47, v49, v13 bitop3:0xf6
  v_max_f32_dpp v44, v44, v44 row_ror:8 row_mask:0xf bank_mask:0xf
  v_bitop3_b32 v47, v47, v50, v14 bitop3:0xf6
  v_mov_b32 v45, v44
  v_bitop3_b32 v47, v47, v51, v15 bitop3:0xf6
  v_bitop3_b32 v47, v47, v52, v12 bitop3:0xf6
  v_permlane16_swap_b32 v44, v45
  v_bitop3_b32 v47, v47, v53, v13 bitop3:0xf6
  v_max_f32 v44, v44, v45
  v_mov_b32 v45, v44
  v_bitop3_b32 v47, v47, v54, v14 bitop3:0xf6
  v_bitop3_b32 v47, v47, v55, v15 bitop3:0xf6
  v_permlane32_swap_b32 v44, v45
  v_bitop3_b32 v47, v47, v56, v12 bitop3:0xf6
  v_max_f32 v44, v44, v45
  v_mul_f32 v44, s62, v44
  v_fma_f32 v140, v140, s62, -v44
  v_fma_f32 v142, v142, s62, -v44
  v_fma_f32 v144, v144, s62, -v44
  v_fma_f32 v146, v146, s62, -v44
  v_exp_f32 v140, v140
  v_exp_f32 v142, v142
  v_exp_f32 v144, v144
  v_exp_f32 v146, v146
  v_bitop3_b32 v47, v47, v57, v13 bitop3:0xf6
  v_mul_f32 v46, v140, v49
  v_fmac_f32 v46, v142, v53
  v_fmac_f32 v46, v144, v57
  v_fmac_f32 v46, v146, v61
  v_bitop3_b32 v47, v47, v58, v14 bitop3:0xf6
  v_bitop3_b32 v47, v47, v59, v15 bitop3:0xf6
  v_add_f32_dpp v46, v46, v46 row_ror:8 row_mask:0xf bank_mask:0xf
  v_bitop3_b32 v47, v47, v60, v12 bitop3:0xf6
  v_mov_b32 v45, v46
  v_bitop3_b32 v47, v47, v61, v13 bitop3:0xf6
  v_bitop3_b32 v47, v47, v62, v14 bitop3:0xf6
  v_permlane16_swap_b32 v46, v45
  v_bitop3_b32 v47, v47, v63, v15 bitop3:0xf6
  v_add_f32 v46, v46, v45
  v_mov_b32 v45, v46
  s_waitcnt vmcnt(0)
  v_pk_mul_f32 v[148:149], v[120:121], v[140:141] op_sel_hi:[1,0]
  v_pk_mul_f32 v[150:151], v[122:123], v[140:141] op_sel_hi:[1,0]
  v_permlane32_swap_b32 v46, v45
  v_pk_fma_f32 v[148:149], v[124:125], v[142:143], v[148:149] op_sel_hi:[1,0,1]
  v_pk_fma_f32 v[150:151], v[126:127], v[142:143], v[150:151] op_sel_hi:[1,0,1]
  v_add_f32 v46, v46, v45
  v_pk_fma_f32 v[148:149], v[128:129], v[144:145], v[148:149] op_sel_hi:[1,0,1]
  v_pk_fma_f32 v[150:151], v[130:131], v[144:145], v[150:151] op_sel_hi:[1,0,1]
  v_rcp_f32 v46, v46
  v_pk_fma_f32 v[148:149], v[132:133], v[146:147], v[148:149] op_sel_hi:[1,0,1]
  v_pk_fma_f32 v[150:151], v[134:135], v[146:147], v[150:151] op_sel_hi:[1,0,1]
  v_bitop3_b32 v47, v47, v120, v12 bitop3:0xf6
  v_permlane32_swap_b32 v148, v149
  v_permlane32_swap_b32 v150, v151
  v_bitop3_b32 v47, v47, v121, v13 bitop3:0xf6
  v_add_f32 v148, v148, v149
  v_add_f32 v150, v150, v151
  v_bitop3_b32 v47, v47, v122, v14 bitop3:0xf6
  v_bitop3_b32 v47, v47, v123, v15 bitop3:0xf6
  v_permlane16_swap_b32 v148, v150
  v_bitop3_b32 v47, v47, v124, v12 bitop3:0xf6
  v_add_f32 v148, v148, v150
  v_bitop3_b32 v47, v47, v125, v13 bitop3:0xf6
  v_bitop3_b32 v47, v47, v126, v14 bitop3:0xf6
  v_add_f32_dpp v148, v148, v148 row_ror:8 row_mask:0xf bank_mask:0xf
  v_bitop3_b32 v47, v47, v127, v15 bitop3:0xf6
  v_mul_f32 v148, v148, v46
  v_cvt_pk_bf16_f32 v148, v148, v148
  ds_write_b32 v8, v148 offset:25600
  v_bitop3_b32 v47, v47, v128, v12 bitop3:0xf6
  v_bitop3_b32 v47, v47, v129, v13 bitop3:0xf6
  v_bitop3_b32 v47, v47, v130, v14 bitop3:0xf6
  v_bitop3_b32 v47, v47, v131, v15 bitop3:0xf6
  v_bitop3_b32 v47, v47, v132, v12 bitop3:0xf6
  v_bitop3_b32 v47, v47, v133, v13 bitop3:0xf6
  v_bitop3_b32 v47, v47, v134, v14 bitop3:0xf6
  v_bitop3_b32 v47, v47, v135, v15 bitop3:0xf6
  v_and_b32 v47, 0xff, v47
  s_waitcnt lgkmcnt(0)
  ds_read_b128 v[152:155], v7 offset:25600
  v_cmp_ne_u32 vcc, 0, v47
  s_cmp_lt_u32 s60, 100000
  s_cselect_b64 vcc, vcc, 0
  s_cmp_lg_u64 vcc, 0
  s_waitcnt lgkmcnt(0)
  s_cbranch_scc1 L_w_h3_15
  v_and_b32 v96, v152, v72
  v_and_b32 v97, v152, v73
  v_and_b32 v98, v152, v74
  v_and_b32 v99, v152, v75
  v_and_b32 v100, v153, v72
  v_and_b32 v101, v153, v73
  v_and_b32 v102, v153, v74
  v_and_b32 v103, v153, v75
  v_mfma_f32_16x16x32_bf16 v[116:119], v[96:99], v[16:19], 0
  v_and_b32 v104, v154, v72
  v_and_b32 v105, v154, v73
  v_and_b32 v106, v154, v74
  v_and_b32 v107, v154, v75
  v_mfma_f32_16x16x32_bf16 v[116:119], v[100:103], v[20:23], v[116:119]
  v_and_b32 v108, v155, v72
  v_and_b32 v109, v155, v73
  v_and_b32 v110, v155, v74
  v_and_b32 v111, v155, v75
  v_mfma_f32_16x16x32_bf16 v[116:119], v[104:107], v[24:27], v[116:119]
  s_nop 0
  v_mfma_f32_16x16x32_bf16 v[116:119], v[108:111], v[28:31], v[116:119]
  s_nop 7
  v_mov_b32 v124, v116
  v_mov_b32 v125, v117
  v_mov_b32 v126, v118
  v_mov_b32 v127, v119
  v_permlane32_swap_b32 v116, v124
  v_permlane32_swap_b32 v117, v125
  v_permlane32_swap_b32 v118, v126
  v_permlane32_swap_b32 v119, v127
  v_add_f32_dpp v116, v124, v116 row_ror:8 row_mask:0xf bank_mask:0xf
  v_add_f32_dpp v117, v125, v117 row_ror:8 row_mask:0xf bank_mask:0xf
  v_add_f32_dpp v118, v126, v118 row_ror:8 row_mask:0xf bank_mask:0xf
  v_add_f32_dpp v119, v127, v119 row_ror:8 row_mask:0xf bank_mask:0xf
  s_mov_b32 exec_lo, 0x00ff00ff
  s_mov_b32 exec_hi, 0
  ds_write_b128 v36, v[116:119] offset:26624
  s_mov_b64 exec, -1
  s_waitcnt lgkmcnt(0)
  s_barrier
  s_cmp_ge_u32 s7, 4
  s_cbranch_scc1 L_w_hi_16
  ds_read_b128 v[120:123], v37 offset:26624
  ds_read_b128 v[124:127], v37 offset:26880
  ds_read_b128 v[128:131], v37 offset:27136
  ds_read_b128 v[132:135], v37 offset:27392
  ds_read_b128 v[136:139], v37 offset:27648
  ds_read_b128 v[140:143], v37 offset:27904
  ds_read_b128 v[144:147], v37 offset:28160
  ds_read_b128 v[148:151], v37 offset:28416
  s_waitcnt lgkmcnt(0)
  v_pk_add_f32 v[120:121], v[120:121], v[124:125]
  v_pk_add_f32 v[122:123], v[122:123], v[126:127]
  v_pk_add_f32 v[128:129], v[128:129], v[132:133]
  v_pk_add_f32 v[130:131], v[130:131], v[134:135]
  v_pk_add_f32 v[136:137], v[136:137], v[140:141]
  v_pk_add_f32 v[138:139], v[138:139], v[142:143]
  v_pk_add_f32 v[144:145], v[144:145], v[148:149]
  v_pk_add_f32 v[146:147], v[146:147], v[150:151]
  v_pk_add_f32 v[120:121], v[120:121], v[128:129]
  v_pk_add_f32 v[122:123], v[122:123], v[130:131]
  v_pk_add_f32 v[136:137], v[136:137], v[144:145]
  v_pk_add_f32 v[138:139], v[138:139], v[146:147]
  v_pk_add_f32 v[120:121], v[120:121], v[136:137]
  v_pk_add_f32 v[122:123], v[122:123], v[138:139]
  v_cvt_pk_bf16_f32 v124, v120, v120
  v_cvt_pk_bf16_f32 v125, v121, v121
  v_cvt_pk_bf16_f32 v126, v122, v122
  v_cvt_pk_bf16_f32 v127, v123, v123
  v_and_b32 v96, v124, v68
  v_and_b32 v97, v124, v69
  v_and_b32 v98, v124, v70
  v_and_b32 v99, v124, v71
  s_nop 1
  v_mfma_f32_16x16x32_bf16 v[136:139], v[96:99], v[160:163], 0
  v_mfma_f32_16x16x32_bf16 v[140:143], v[96:99], v[164:167], 0
  v_mfma_f32_16x16x32_bf16 v[144:147], v[96:99], v[168:171], 0
  v_mfma_f32_16x16x32_bf16 v[148:151], v[96:99], v[172:175], 0
  v_mfma_f32_16x16x32_bf16 v[152:155], v[96:99], v[176:179], 0
  v_and_b32 v100, v125, v68
  v_and_b32 v101, v125, v69
  v_and_b32 v102, v125, v70
  v_and_b32 v103, v125, v71
  s_nop 1
  v_mfma_f32_16x16x32_bf16 v[136:139], v[100:103], v[180:183], v[136:139]
  v_mfma_f32_16x16x32_bf16 v[140:143], v[100:103], v[184:187], v[140:143]
  v_mfma_f32_16x16x32_bf16 v[144:147], v[100:103], v[188:191], v[144:147]
  v_mfma_f32_16x16x32_bf16 v[148:151], v[100:103], v[192:195], v[148:151]
  v_mfma_f32_16x16x32_bf16 v[152:155], v[100:103], v[196:199], v[152:155]
  v_and_b32 v104, v126, v68
  v_and_b32 v105, v126, v69
  v_and_b32 v106, v126, v70
  v_and_b32 v107, v126, v71
  s_nop 1
  v_mfma_f32_16x16x32_bf16 v[136:139], v[104:107], v[200:203], v[136:139]
  v_mfma_f32_16x16x32_bf16 v[140:143], v[104:107], v[204:207], v[140:143]
  v_mfma_f32_16x16x32_bf16 v[144:147], v[104:107], v[208:211], v[144:147]
  v_mfma_f32_16x16x32_bf16 v[148:151], v[104:107], v[212:215], v[148:151]
  v_mfma_f32_16x16x32_bf16 v[152:155], v[104:107], v[216:219], v[152:155]
  v_and_b32 v108, v127, v68
  v_and_b32 v109, v127, v69
  v_and_b32 v110, v127, v70
  v_and_b32 v111, v127, v71
  s_nop 1
  v_mfma_f32_16x16x32_bf16 v[136:139], v[108:111], v[220:223], v[136:139]
  v_mfma_f32_16x16x32_bf16 v[140:143], v[108:111], v[224:227], v[140:143]
  v_mfma_f32_16x16x32_bf16 v[144:147], v[108:111], v[228:231], v[144:147]
  v_mfma_f32_16x16x32_bf16 v[148:151], v[108:111], v[232:235], v[148:151]
  v_mfma_f32_16x16x32_bf16 v[152:155], v[108:111], v[236:239], v[152:155]
  s_mov_b32 exec_hi, 0
  s_nop 3
  ds_write_b128 v38, v[136:139] offset:28672
  ds_write_b128 v38, v[140:143] offset:29184
  ds_write_b128 v38, v[144:147] offset:29696
  ds_write_b128 v38, v[148:151] offset:30208
  s_nop 3
  ds_write_b128 v38, v[152:155] offset:30720
  s_mov_b64 exec, -1
  s_waitcnt lgkmcnt(0)
  s_barrier
  s_cmp_ge_u32 s4, 40
  s_cbranch_scc1 L_fin
  s_cmp_lg_u32 s7, 0
  s_cbranch_scc1 L_fin
  v_and_b32 v8, 1, v3
  v_lshlrev_b32 v8, 1, v8
  v_lshrrev_b32 v9, 1, v3
  v_or_b32 v8, v8, v9
  v_and_b32 v9, 3, v1
  v_lshl_add_u32 v8, v9, 2, v8
  s_mov_b32 s44, s16
  s_and_b32 s45, s17, 0xffff
  s_mov_b32 s46, 1280
  s_mov_b32 s47, 0x00020000
  s_mov_b32 s52, s34
  s_and_b32 s53, s35, 0xffff
  s_mov_b32 s54, 1280
  s_mov_b32 s55, 0x00020000
  s_lshl_b32 s12, s4, 5
  v_lshlrev_b32 v9, 1, v8
  buffer_load_ushort v50, v9, s[44:47], s12 offen
  s_mul_i32 s12, s4, 7168
  s_add_u32 s12, s12, 3248128
  s_add_u32 s13, s12, 4096
  v_cmp_gt_u32 vcc, 48, v1
  v_add_u32 v10, 1024, v5
  s_nop 0
  v_cndmask_b32 v10, v5, v10, vcc
  v_bfe_u32 v51, v1, 2, 3
  v_mul_u32_u24 v51, 2560, v51
  v_and_b32 v52, 3, v1
  v_lshl_add_u32 v51, v52, 4, v51
  s_lshl_b32 s14, s4, 6
  s_add_u32 s14, s14, 3227648
  s_lshl_b32 s70, s4, 7
  s_add_u32 s70, s70, 3604480
  s_mov_b32 s60, 0
L_sg_17:
  s_load_dwordx2 s[28:29], s[38:39], s72 glc
  s_add_u32 s60, s60, 1
  s_cmp_ge_u32 s60, 100000
  s_cbranch_scc1 L_sgd_18
  s_waitcnt lgkmcnt(0)
  s_cmp_lg_u32 s28, s65
  s_cbranch_scc1 L_sg_17
L_un_19:
  s_memrealtime s[0:1]
  s_waitcnt lgkmcnt(0)
  s_sub_u32 s0, s0, s29
  s_cmp_lt_u32 s0, 67
  s_cbranch_scc1 L_un_19
L_sgd_18:
  s_waitcnt lgkmcnt(0)
  s_mov_b32 s60, 0
L_pl_20:
  buffer_load_dwordx4 v[44:47], v51, s[40:43], s14 offen sc1
  s_add_u32 s60, s60, 1
  s_cmp_ge_u32 s60, 100000
  s_cbranch_scc1 L_pld_21
  s_waitcnt vmcnt(0)
  v_xor_b32 v53, v44, v12
  v_bitop3_b32 v53, v53, v45, v13 bitop3:0xf6
  v_bitop3_b32 v53, v53, v46, v14 bitop3:0xf6
  v_bitop3_b32 v53, v53, v47, v15 bitop3:0xf6
  v_and_b32 v53, 0xff, v53
  v_cmp_ne_u32 vcc, 0, v53
  s_cmp_lg_u64 vcc, 0
  s_cbranch_scc1 L_pl_20
L_pld_21:
  s_waitcnt vmcnt(0)
  v_cmp_gt_u32 vcc, 32, v1
  s_nop 1
  v_cndmask_b32 v44, 0, v44, vcc
  v_cndmask_b32 v45, 0, v45, vcc
  v_cndmask_b32 v46, 0, v46, vcc
  v_cndmask_b32 v47, 0, v47, vcc
  s_nop 1
  v_permlane32_swap_b32 v44, v45
  v_permlane32_swap_b32 v46, v47
  s_nop 0
  v_add_f32 v44, v44, v45
  v_add_f32 v46, v46, v47
  s_nop 1
  v_permlane16_swap_b32 v44, v46
  s_nop 0
  v_add_f32 v44, v44, v46
  s_nop 1
  v_add_f32_dpp v44, v44, v44 row_ror:8 row_mask:0xf bank_mask:0xf
  s_nop 1
  v_add_f32_dpp v44, v44, v44 row_ror:4 row_mask:0xf bank_mask:0xf
  v_cvt_pk_bf16_f32 v44, v44, v44
  v_and_b32 v44, 0xffff0000, v44
  v_lshlrev_b32 v50, 16, v50
  v_add_f32 v44, v44, v50
  v_cvt_pk_bf16_f32 v44, v44, v44
  v_and_b32 v44, 0xffff0000, v44
  s_lshl_b32 s15, s4, 5
  s_mov_b32 s62, 0x000f000f
  s_mov_b32 s63, 0x000f000f
  v_cmp_gt_u32 s[68:69], 48, v1
  s_mov_b32 s60, 0
L_sg_22:
  s_load_dwordx2 s[28:29], s[38:39], s70 glc
  s_add_u32 s60, s60, 1
  s_cmp_ge_u32 s60, 100000
  s_cbranch_scc1 L_sgd_23
  s_waitcnt lgkmcnt(0)
  s_cmp_lg_u32 s28, s65
  s_cbranch_scc1 L_sg_22
L_un_24:
  s_memrealtime s[0:1]
  s_waitcnt lgkmcnt(0)
  s_sub_u32 s0, s0, s29
  s_cmp_lt_u32 s0, 45
  s_cbranch_scc1 L_un_24
L_sgd_23:
  s_waitcnt lgkmcnt(0)
  s_mov_b32 s60, 0
L_ps_25:
  buffer_load_dwordx4 v[40:43], v10, s[40:43], s13 offen offset:1024 sc1
  buffer_load_dwordx4 v[16:19], v5, s[40:43], s12 offen offset:0 sc1
  buffer_load_dwordx4 v[20:23], v5, s[40:43], s12 offen offset:1024 sc1
  buffer_load_dwordx4 v[24:27], v5, s[40:43], s12 offen offset:2048 sc1
  buffer_load_dwordx4 v[28:31], v5, s[40:43], s12 offen offset:3072 sc1
  buffer_load_dwordx4 v[32:35], v5, s[40:43], s13 offen offset:0 sc1
  buffer_load_dwordx4 v[36:39], v5, s[40:43], s13 offen offset:1024 sc1
  s_add_u32 s60, s60, 1
  s_waitcnt vmcnt(6)
  v_xor_b32 v53, v40, v12
  v_bitop3_b32 v53, v53, v41, v13 bitop3:0xf6
  v_bitop3_b32 v53, v53, v42, v14 bitop3:0xf6
  v_bitop3_b32 v53, v53, v43, v15 bitop3:0xf6
  v_cndmask_b32 v40, 0, v40, s[68:69]
  v_cndmask_b32 v41, 0, v41, s[68:69]
  v_cndmask_b32 v42, 0, v42, s[68:69]
  v_cndmask_b32 v43, 0, v43, s[68:69]
  s_waitcnt vmcnt(5)
  v_bitop3_b32 v53, v53, v16, v12 bitop3:0xf6
  v_bitop3_b32 v53, v53, v17, v13 bitop3:0xf6
  v_bitop3_b32 v53, v53, v18, v14 bitop3:0xf6
  v_bitop3_b32 v53, v53, v19, v15 bitop3:0xf6
  v_pk_add_f32 v[56:57], v[40:41], v[16:17]
  v_pk_add_f32 v[58:59], v[42:43], v[18:19]
  s_waitcnt vmcnt(4)
  v_bitop3_b32 v53, v53, v20, v12 bitop3:0xf6
  v_bitop3_b32 v53, v53, v21, v13 bitop3:0xf6
  v_bitop3_b32 v53, v53, v22, v14 bitop3:0xf6
  v_bitop3_b32 v53, v53, v23, v15 bitop3:0xf6
  v_pk_add_f32 v[56:57], v[56:57], v[20:21]
  v_pk_add_f32 v[58:59], v[58:59], v[22:23]
  s_waitcnt vmcnt(3)
  v_bitop3_b32 v53, v53, v24, v12 bitop3:0xf6
  v_bitop3_b32 v53, v53, v25, v13 bitop3:0xf6
  v_bitop3_b32 v53, v53, v26, v14 bitop3:0xf6
  v_bitop3_b32 v53, v53, v27, v15 bitop3:0xf6
  v_pk_add_f32 v[56:57], v[56:57], v[24:25]
  v_pk_add_f32 v[58:59], v[58:59], v[26:27]
  s_waitcnt vmcnt(2)
  v_bitop3_b32 v53, v53, v28, v12 bitop3:0xf6
  v_bitop3_b32 v53, v53, v29, v13 bitop3:0xf6
  v_bitop3_b32 v53, v53, v30, v14 bitop3:0xf6
  v_bitop3_b32 v53, v53, v31, v15 bitop3:0xf6
  v_pk_add_f32 v[56:57], v[56:57], v[28:29]
  v_pk_add_f32 v[58:59], v[58:59], v[30:31]
  s_waitcnt vmcnt(1)
  v_bitop3_b32 v53, v53, v32, v12 bitop3:0xf6
  v_bitop3_b32 v53, v53, v33, v13 bitop3:0xf6
  v_bitop3_b32 v53, v53, v34, v14 bitop3:0xf6
  v_bitop3_b32 v53, v53, v35, v15 bitop3:0xf6
  v_pk_add_f32 v[56:57], v[56:57], v[32:33]
  v_pk_add_f32 v[58:59], v[58:59], v[34:35]
  s_waitcnt vmcnt(0)
  v_bitop3_b32 v53, v53, v36, v12 bitop3:0xf6
  v_bitop3_b32 v53, v53, v37, v13 bitop3:0xf6
  v_bitop3_b32 v53, v53, v38, v14 bitop3:0xf6
  v_bitop3_b32 v53, v53, v39, v15 bitop3:0xf6
  v_pk_add_f32 v[56:57], v[56:57], v[36:37]
  v_pk_add_f32 v[58:59], v[58:59], v[38:39]
  v_and_b32 v53, 0xff, v53
  v_cmp_ne_u32 vcc, 0, v53
  s_cmp_lt_u32 s60, 100000
  s_cselect_b64 vcc, vcc, 0
  s_cmp_lg_u64 vcc, 0
  s_cbranch_scc1 L_ps_25
  s_nop 1
  v_permlane32_swap_b32 v56, v57
  v_permlane32_swap_b32 v58, v59
  s_nop 0
  v_add_f32 v56, v56, v57
  v_add_f32 v58, v58, v59
  s_nop 1
  v_permlane16_swap_b32 v56, v58
  s_nop 0
  v_add_f32 v56, v56, v58
  s_nop 1
  v_add_f32_dpp v56, v56, v56 row_ror:8 row_mask:0xf bank_mask:0xf
  s_nop 1
  v_add_f32_dpp v56, v56, v56 row_ror:4 row_mask:0xf bank_mask:0xf
  s_nop 0
  v_cvt_pk_bf16_f32 v16, v56, v56
  v_and_b32 v16, 0xffff0000, v16
  v_add_f32 v16, v16, v44
  v_cvt_pk_bf16_f32 v16, v16, v16
  s_mov_b64 exec, s[62:63]
  buffer_store_short v16, v9, s[52:55], s15 offen
  s_mov_b64 exec, -1
  s_branch L_fin
L_w_hi_16:
  s_sub_u32 s10, s7, 4
  s_lshl_b32 s10, s10, 4
  s_add_u32 s10, s10, s9
  s_mul_i32 s12, s8, 20
  s_add_u32 s12, s12, s10
  s_lshl_b32 s12, s12, 11
  s_add_u32 s12, s12, 2899968
  s_mul_i32 s13, s8, 2560
  s_lshl_b32 s14, s10, 7
  s_add_u32 s13, s13, s14
  s_add_u32 s13, s13, 3227648
  v_cmp_gt_u32 vcc, 160, v39
  s_and_saveexec_b64 s[62:63], vcc
  s_barrier
  s_cbranch_execz L_fin
  ds_read_b128 v[120:123], v41 offset:28672
  ds_read_b128 v[124:127], v41 offset:31232
  ds_read_b128 v[128:131], v41 offset:33792
  ds_read_b128 v[132:135], v41 offset:36352
  s_waitcnt lgkmcnt(0)
  v_pk_add_f32 v[120:121], v[120:121], v[124:125]
  v_pk_add_f32 v[122:123], v[122:123], v[126:127]
  v_pk_add_f32 v[128:129], v[128:129], v[132:133]
  v_pk_add_f32 v[130:131], v[130:131], v[134:135]
  v_pk_add_f32 v[120:121], v[120:121], v[128:129]
  v_pk_add_f32 v[122:123], v[122:123], v[130:131]
  v_and_or_b32 v120, v120, s64, v12
  v_and_or_b32 v121, v121, s64, v13
  v_and_or_b32 v122, v122, s64, v14
  v_and_or_b32 v123, v123, s64, v15
  buffer_store_dwordx4 v[120:123], v40, s[40:43], s69 offen
  s_cmp_ge_u32 s10, 20
  s_cbranch_scc1 L_w_nored_26
  s_mov_b32 s60, 0
L_pl_27:
  buffer_load_dwordx4 v[124:127], v5, s[40:43], s12 offen offset:0 sc1
  buffer_load_dwordx4 v[128:131], v5, s[40:43], s12 offen offset:1024 sc1
  s_add_u32 s60, s60, 1
  s_cmp_lg_u32 s60, 10
  s_cbranch_scc1 L_pnr_29
  buffer_store_dwordx4 v[120:123], v40, s[40:43], s69 offen sc1
L_pnr_29:
  s_cmp_ge_u32 s60, 100000
  s_cbranch_scc1 L_pld_28
  s_waitcnt vmcnt(0)
  v_xor_b32 v44, v124, v12
  v_bitop3_b32 v44, v44, v125, v13 bitop3:0xf6
  v_bitop3_b32 v44, v44, v126, v14 bitop3:0xf6
  v_bitop3_b32 v44, v44, v127, v15 bitop3:0xf6
  v_bitop3_b32 v44, v44, v128, v12 bitop3:0xf6
  v_bitop3_b32 v44, v44, v129, v13 bitop3:0xf6
  v_bitop3_b32 v44, v44, v130, v14 bitop3:0xf6
  v_bitop3_b32 v44, v44, v131, v15 bitop3:0xf6
  v_and_b32 v44, 0xff, v44
  v_cmp_ne_u32 vcc, 0, v44
  s_cmp_lg_u64 vcc, 0
  s_cbranch_scc1 L_pl_27
L_pld_28:
  s_waitcnt vmcnt(0)
  s_cmp_lg_u32 s7, 4
  s_cbranch_scc1 L_w_nosig_30
  s_memrealtime s[0:1]
  s_waitcnt lgkmcnt(0)
  v_mov_b32 v43, s0
  buffer_store_dwordx2 v[42:43], v11, s[40:43], s72 offen sc1
L_w_nosig_30:
  v_pk_add_f32 v[124:125], v[124:125], v[128:129]
  v_pk_add_f32 v[126:127], v[126:127], v[130:131]
  s_nop 0
  v_add_f32_dpp v124, v124, v124 row_ror:8 row_mask:0xf bank_mask:0xf
  v_add_f32_dpp v125, v125, v125 row_ror:8 row_mask:0xf bank_mask:0xf
  v_add_f32_dpp v126, v126, v126 row_ror:8 row_mask:0xf bank_mask:0xf
  v_add_f32_dpp v127, v127, v127 row_ror:8 row_mask:0xf bank_mask:0xf
  v_mov_b32 v128, v124
  v_mov_b32 v129, v125
  v_mov_b32 v130, v126
  v_mov_b32 v131, v127
  v_permlane16_swap_b32 v124, v128
  v_permlane16_swap_b32 v125, v129
  v_permlane16_swap_b32 v126, v130
  v_permlane16_swap_b32 v127, v131
  v_pk_add_f32 v[124:125], v[124:125], v[128:129]
  v_pk_add_f32 v[126:127], v[126:127], v[130:131]
  v_mov_b32 v128, v124
  v_mov_b32 v129, v125
  v_mov_b32 v130, v126
  v_mov_b32 v131, v127
  v_permlane32_swap_b32 v124, v128
  v_permlane32_swap_b32 v125, v129
  v_permlane32_swap_b32 v126, v130
  v_permlane32_swap_b32 v127, v131
  v_pk_add_f32 v[124:125], v[124:125], v[128:129]
  v_pk_add_f32 v[126:127], v[126:127], v[130:131]
  v_and_or_b32 v124, v124, s64, v12
  v_and_or_b32 v125, v125, s64, v13
  v_and_or_b32 v126, v126, s64, v14
  v_and_or_b32 v127, v127, s64, v15
  s_mov_b64 exec, 0xff
  buffer_store_dwordx4 v[124:127], v5, s[40:43], s13 offen sc1
  s_mov_b64 exec, -1
L_w_nored_26:
  s_sleep 64
  buffer_store_dwordx4 v[120:123], v40, s[40:43], s69 offen sc1
  s_branch L_fin
L_kv_w0:
  s_bfe_u32 s10, s9, 0x20002
  s_lshl_b32 s5, s8, 2
  s_add_u32 s5, s5, s10
  s_and_b32 s6, s9, 3
  s_mov_b32 s44, s18
  s_and_b32 s45, s19, 0xffff
  s_mov_b32 s46, 8388608
  s_mov_b32 s47, 0x00020000
  s_lshl_b32 s10, s5, 3
  s_lshl_b32 s11, s6, 1
  s_add_u32 s10, s10, s11
  s_mul_i32 s68, s10, 2304
  s_add_u32 s68, s68, 196608
  s_lshl_b32 s69, s5, 7
  s_add_u32 s69, s69, 3620864
  s_branch L_kv_join
L_kv_lo:
  s_bfe_u32 s10, s9, 0x20002
  s_lshl_b32 s5, s8, 2
  s_add_u32 s5, s5, s10
  s_and_b32 s6, s9, 3
  s_mov_b32 s44, s18
  s_and_b32 s45, s19, 0xffff
  s_mov_b32 s46, 8388608
  s_mov_b32 s47, 0x00020000
  s_lshl_b32 s10, s5, 3
  s_lshl_b32 s11, s6, 1
  s_add_u32 s10, s10, s11
  s_mul_i32 s68, s10, 2304
  s_add_u32 s68, s68, 196608
  s_lshl_b32 s69, s5, 7
  s_add_u32 s69, s69, 3620864
  s_sub_u32 s15, s7, 1
  s_lshl_b32 s12, s5, 8
  s_lshl_b32 s13, s6, 6
  s_add_u32 s12, s12, s13
  s_add_u32 s12, s12, s15
  s_lshl_b32 s12, s12, 10
  s_mul_i32 s14, s15, 1040
  s_add_u32 s14, s14, 0
  s_mov_b32 m0, s14
  s_add_u32 s14, s14, 6240
  buffer_load_dwordx4 v5, s[44:47], s12 offen  lds
  s_add_u32 s12, s12, 6144
  s_mov_b32 m0, s14
  s_add_u32 s14, s14, 6240
  buffer_load_dwordx4 v5, s[44:47], s12 offen  lds
  s_add_u32 s12, s12, 6144
  s_mov_b32 m0, s14
  s_add_u32 s14, s14, 6240
  buffer_load_dwordx4 v5, s[44:47], s12 offen  lds
  s_add_u32 s12, s12, 6144
  s_mov_b32 m0, s14
  s_add_u32 s14, s14, 6240
  buffer_load_dwordx4 v5, s[44:47], s12 offen  lds
  s_add_u32 s12, s12, 6144
  s_mov_b32 m0, s14
  s_add_u32 s14, s14, 6240
  buffer_load_dwordx4 v5, s[44:47], s12 offen  lds
  s_add_u32 s12, s12, 6144
  s_mov_b32 m0, s14
  s_add_u32 s14, s14, 6240
  buffer_load_dwordx4 v5, s[44:47], s12 offen  lds
  s_add_u32 s12, s12, 6144
  s_mov_b32 m0, s14
  s_add_u32 s14, s14, 6240
  buffer_load_dwordx4 v5, s[44:47], s12 offen  lds
  s_add_u32 s12, s12, 6144
  s_mov_b32 m0, s14
  s_add_u32 s14, s14, 6240
  buffer_load_dwordx4 v5, s[44:47], s12 offen  lds
  s_add_u32 s12, s12, 6144
  s_mov_b32 m0, s14
  s_add_u32 s14, s14, 6240
  buffer_load_dwordx4 v5, s[44:47], s12 offen  lds
  s_add_u32 s12, s12, 6144
  s_mov_b32 m0, s14
  s_add_u32 s14, s14, 6240
  buffer_load_dwordx4 v5, s[44:47], s12 offen  lds
  s_add_u32 s12, s12, 6144
  s_cmp_ge_u32 s15, 4
  s_cbranch_scc1 L_kv_join
  s_mov_b32 m0, s14
  s_add_u32 s14, s14, 6240
  buffer_load_dwordx4 v5, s[44:47], s12 offen  lds
  s_add_u32 s12, s12, 6144
  s_branch L_kv_join
L_kv_hi:
  s_bfe_u32 s10, s9, 0x20002
  s_lshl_b32 s5, s8, 2
  s_add_u32 s5, s5, s10
  s_and_b32 s6, s9, 3
  s_mov_b32 s44, s18
  s_and_b32 s45, s19, 0xffff
  s_mov_b32 s46, 8388608
  s_mov_b32 s47, 0x00020000
  s_lshl_b32 s10, s5, 3
  s_lshl_b32 s11, s6, 1
  s_add_u32 s10, s10, s11
  s_mul_i32 s68, s10, 2304
  s_add_u32 s68, s68, 196608
  s_lshl_b32 s69, s5, 7
  s_add_u32 s69, s69, 3620864
  s_cmp_eq_u32 s7, 7
  s_cbranch_scc1 L_kv_w7_31
  s_sleep 14
  s_sub_u32 s15, s7, 1
  s_lshl_b32 s12, s5, 8
  s_lshl_b32 s13, s6, 6
  s_add_u32 s12, s12, s13
  s_add_u32 s12, s12, s15
  s_lshl_b32 s12, s12, 10
  s_mul_i32 s14, s15, 1040
  s_add_u32 s14, s14, 0
  s_mov_b32 m0, s14
  s_add_u32 s14, s14, 6240
  buffer_load_dwordx4 v5, s[44:47], s12 offen  lds
  s_add_u32 s12, s12, 6144
  s_mov_b32 m0, s14
  s_add_u32 s14, s14, 6240
  buffer_load_dwordx4 v5, s[44:47], s12 offen  lds
  s_add_u32 s12, s12, 6144
  s_mov_b32 m0, s14
  s_add_u32 s14, s14, 6240
  buffer_load_dwordx4 v5, s[44:47], s12 offen  lds
  s_add_u32 s12, s12, 6144
  s_mov_b32 m0, s14
  s_add_u32 s14, s14, 6240
  buffer_load_dwordx4 v5, s[44:47], s12 offen  lds
  s_add_u32 s12, s12, 6144
  s_mov_b32 m0, s14
  s_add_u32 s14, s14, 6240
  buffer_load_dwordx4 v5, s[44:47], s12 offen  lds
  s_add_u32 s12, s12, 6144
  s_mov_b32 m0, s14
  s_add_u32 s14, s14, 6240
  buffer_load_dwordx4 v5, s[44:47], s12 offen  lds
  s_add_u32 s12, s12, 6144
  s_mov_b32 m0, s14
  s_add_u32 s14, s14, 6240
  buffer_load_dwordx4 v5, s[44:47], s12 offen  lds
  s_add_u32 s12, s12, 6144
  s_mov_b32 m0, s14
  s_add_u32 s14, s14, 6240
  buffer_load_dwordx4 v5, s[44:47], s12 offen  lds
  s_add_u32 s12, s12, 6144
  s_mov_b32 m0, s14
  s_add_u32 s14, s14, 6240
  buffer_load_dwordx4 v5, s[44:47], s12 offen  lds
  s_add_u32 s12, s12, 6144
  s_mov_b32 m0, s14
  s_add_u32 s14, s14, 6240
  buffer_load_dwordx4 v5, s[44:47], s12 offen  lds
  s_add_u32 s12, s12, 6144
  s_cmp_ge_u32 s15, 4
  s_cbranch_scc1 L_kv_rowsd_32
  s_mov_b32 m0, s14
  s_add_u32 s14, s14, 6240
  buffer_load_dwordx4 v5, s[44:47], s12 offen  lds
  s_add_u32 s12, s12, 6144
L_kv_rowsd_32:
  s_barrier
  s_branch L_kv_join
L_kv_w7_31:
  v_mov_b32 v20, -1
  v_mov_b32 v21, -1
  v_mov_b32 v22, -1
  v_mov_b32 v23, -1
  buffer_store_dwordx4 v[20:23], v5, s[40:43], s68 offen sc1
  buffer_store_dwordx4 v[20:23], v5, s[40:43], s68 offen offset:1024 sc1
  buffer_store_dwordx4 v[20:23], v5, s[40:43], s68 offen offset:2048 sc1
  buffer_store_dwordx4 v[20:23], v5, s[40:43], s68 offen offset:3072 sc1
  buffer_store_dwordx4 v[20:23], v5, s[40:43], s68 offen offset:3584 sc1
  ds_write_b32 v227, v11 offset:16
  ds_write_b32 v227, v11 offset:20
  s_waitcnt lgkmcnt(0)
  s_barrier
  ds_read_b32 v60, v227 offset:0
  s_lshl_b32 s12, s6, 4
  s_add_u32 s12, s12, s69
  s_waitcnt vmcnt(0) lgkmcnt(0)
  s_getreg_b32 s13, hwreg(HW_REG_XCC_ID)
  v_mov_b32 v61, s13
  v_mov_b32 v62, v60
  v_mov_b32 v63, v60
  s_mov_b64 exec, 1
  buffer_store_dwordx4 v[60:63], v11, s[40:43], s12 offen sc1
  s_mov_b64 exec, -1
  v_readfirstlane_b32 s65, v60
  s_mov_b32 s60, 0
L_kv_rdy_33:
  s_load_dwordx16 s[76:91], s[38:39], s69 glc
  s_add_u32 s60, s60, 1
  s_cmp_ge_u32 s60, 100000
  s_cbranch_scc1 L_kv_rdyd_34
  s_waitcnt lgkmcnt(0)
  s_xor_b32 s76, s76, s65
  s_xor_b32 s80, s80, s65
  s_xor_b32 s84, s84, s65
  s_xor_b32 s88, s88, s65
  s_or_b32 s76, s76, s80
  s_or_b32 s84, s84, s88
  s_or_b32 s76, s76, s84
  s_cbranch_scc1 L_kv_rdy_33
L_kv_rdyd_34:
  s_waitcnt lgkmcnt(0)
  s_xor_b32 s77, s77, s13
  s_xor_b32 s81, s81, s13
  s_xor_b32 s85, s85, s13
  s_xor_b32 s89, s89, s13
  s_or_b32 s77, s77, s81
  s_or_b32 s85, s85, s89
  s_or_b32 s77, s77, s85
  v_mov_b32 v8, s77
  ds_write_b32 v227, v8 offset:8
  s_mul_i32 s12, s5, 18432
  s_add_u32 s12, s12, 196608
  v_mul_u32_u24 v8, 96, v1
  buffer_load_dword v250, v8, s[40:43], s12 offen sc1
  s_add_u32 s12, s12, 6144
  buffer_load_dword v251, v8, s[40:43], s12 offen sc1
  s_add_u32 s12, s12, 6144
  buffer_load_dword v252, v8, s[40:43], s12 offen sc1
  s_waitcnt lgkmcnt(0)
L_kv_join:
  s_lshr_b32 s10, s7, 2
  s_lshl_b32 s10, s10, 7
  s_bfe_u32 s11, s7, 0x10001
  s_mul_i32 s11, s11, 33280
  s_add_u32 s10, s10, s11
  s_add_u32 s10, s10, 0
  v_mul_u32_u24 v231, 1040, v2
  v_lshl_add_u32 v231, v3, 8, v231
  v_add_u32 v231, s10, v231
  s_lshl_b32 s48, s7, 10
  s_add_u32 s49, s48, 131072
  s_add_u32 s48, s48, 4096
  s_lshr_b32 s10, s7, 2
  s_mul_i32 s10, s10, 22528
  s_and_b32 s11, s7, 1
  s_mul_i32 s12, s11, 5632
  s_add_u32 s10, s10, s12
  v_mov_b32 v10, v5
  v_lshrrev_b32 v6, 1, v3
  v_lshl_add_u32 v6, v6, 5, v2
  v_mul_u32_u24 v6, 352, v6
  v_and_b32 v8, 1, v3
  v_lshl_add_u32 v6, v8, 4, v6
  v_add_u32 v6, s10, v6
  s_and_b32 s10, s7, 3
  s_lshl_b32 s10, s10, 11
  v_add_u32 v9, s10, v5
  s_lshl_b32 s10, s7, 11
  v_add_u32 v7, s10, v5
  s_and_b32 s10, s7, 3
  s_mul_i32 s10, s10, 1152
  s_add_u32 s50, s68, s10
  v_lshlrev_b32 v212, 3, v2
  s_mul_i32 s51, s5, 18432
  s_mul_i32 s10, s7, 2304
  s_add_u32 s51, s51, s10
  s_add_u32 s51, s51, 196608
  v_and_b32 v213, 1, v3
  v_mul_u32_u24 v213, 1152, v213
  v_add_u32 v213, v213, v212
  v_and_b32 v214, 31, v1
  v_lshlrev_b32 v214, 4, v214
  s_lshr_b32 s10, s7, 1
  s_lshl_b32 s10, s10, 9
  s_and_b32 s12, s7, 1
  s_lshl_b32 s12, s12, 3
  s_add_u32 s10, s10, s12
  v_add_u32 v214, s10, v214
  s_lshl_b32 s10, s11, 10
  v_add_u32 v215, s10, v10
  s_lshl_b32 s10, s11, 4
  v_add_u32 v216, s10, v2
  v_lshlrev_b32 v217, 4, v216
  v_lshlrev_b32 v218, 16, v216
  v_lshl_add_u32 v218, v3, 4, v218
  s_lshl_b32 s52, s6, 5
  s_add_u32 s52, s52, s5
  s_lshl_b32 s52, s52, 9
  s_lshr_b32 s10, s7, 1
  s_lshl_b32 s10, s10, 7
  s_add_u32 s52, s52, s10
  s_add_u32 s52, s52, 786432
  v_lshlrev_b32 v219, 9, v216
  s_lshl_b32 s53, s5, 4
  s_add_u32 s53, s53, 2883584
  s_mov_b32 s54, 0x3db504f3
  s_mov_b32 s55, 0x3fb8aa3b
  v_mov_b32 v221, 1
  v_lshlrev_b32 v8, 1, v3
  v_xor_b32 v8, v8, v2
  v_lshlrev_b32 v222, 10, v3
  v_lshl_add_u32 v222, v8, 4, v222
  v_xor_b32 v226, 0x80, v222
  s_lshl_b32 s74, s5, 8
  s_lshl_b32 s13, s7, 5
  s_add_u32 s74, s74, s13
  s_lshl_b32 s74, s74, 10
  s_lshl_b32 s14, s6, 8
  s_add_u32 s74, s74, s14
  s_lshl_b32 s75, s7, 13
  s_add_u32 s75, s75, 67584
  v_lshrrev_b32 v223, 2, v2
  v_lshl_add_u32 v223, v3, 2, v223
  v_and_b32 v229, 7, v223
  s_lshr_b32 s12, s7, 1
  s_lshl_b32 s12, s12, 1
  v_xor_b32 v229, s12, v229
  v_lshlrev_b32 v223, 8, v223
  v_lshl_add_u32 v223, v229, 5, v223
  v_and_b32 v8, 3, v2
  v_lshl_add_u32 v223, v8, 3, v223
  v_add_u32 v223, 67584, v223
  v_xor_b32 v229, 32, v223
  v_add_u32 v230, 12, v5
  v_add_u32 v230, s48, v230
  s_lshl_b32 s70, s4, 7
  s_add_u32 s70, s70, 3538944
  s_lshl_b32 s71, s4, 7
  s_add_u32 s71, s71, 3555328
  s_lshl_b32 s72, s4, 7
  s_add_u32 s72, s72, 3571712
  ds_read_b32 v240, v227 offset:0
  s_waitcnt lgkmcnt(0)
  v_readfirstlane_b32 s65, v240
  s_mov_b32 s64, 0xffffff00
  s_and_b32 s61, s65, 0xff
  v_mov_b32 v12, s61
  s_bfe_u32 s61, s65, 0x80008
  v_mov_b32 v13, s61
  s_bfe_u32 s61, s65, 0x80010
  v_mov_b32 v14, s61
  s_lshr_b32 s61, s65, 24
  v_mov_b32 v15, s61
  s_and_b32 s67, s65, 0xbfffbfff
  v_mov_b32 v220, s65
  s_mov_b32 s3, 0
  v_mov_b32 v232, v120
  v_mov_b32 v233, v121
  v_mov_b32 v234, v122
  v_mov_b32 v235, v123
  s_cmp_eq_u32 s7, 7
  s_cbranch_scc1 L_kv_b7_35
  s_mov_b32 m0, s75
  s_add_u32 s75, s75, 1024
  buffer_load_dwordx4 v222, s[44:47], s74 offen  lds
  s_add_u32 s74, s74, 4096
  s_mov_b32 m0, s75
  s_add_u32 s75, s75, 1024
  buffer_load_dwordx4 v226, s[44:47], s74 offen  lds
  s_add_u32 s74, s74, 4096
  s_mov_b32 m0, s75
  s_add_u32 s75, s75, 1024
  buffer_load_dwordx4 v222, s[44:47], s74 offen  lds
  s_add_u32 s74, s74, 4096
  s_mov_b32 m0, s75
  s_add_u32 s75, s75, 1024
  buffer_load_dwordx4 v226, s[44:47], s74 offen  lds
  s_add_u32 s74, s74, 4096
  s_mov_b32 m0, s75
  s_add_u32 s75, s75, 1024
  buffer_load_dwordx4 v222, s[44:47], s74 offen  lds
  s_add_u32 s74, s74, 4096
  s_mov_b32 m0, s75
  s_add_u32 s75, s75, 1024
  buffer_load_dwordx4 v226, s[44:47], s74 offen  lds
  s_add_u32 s74, s74, 4096
  s_mov_b32 m0, s75
  s_add_u32 s75, s75, 1024
  buffer_load_dwordx4 v222, s[44:47], s74 offen  lds
  s_add_u32 s74, s74, 4096
  s_mov_b32 m0, s75
  s_add_u32 s75, s75, 1024
  buffer_load_dwordx4 v226, s[44:47], s74 offen  lds
  s_add_u32 s74, s74, 4096
  s_cmp_lg_u32 s7, 0
  s_cbranch_scc1 L_kv_b0_36
  s_add_u32 s74, s74, 196608
  s_add_u32 s75, s75, 49152
  s_mov_b32 m0, s75
  s_add_u32 s75, s75, 1024
  buffer_load_dwordx4 v222, s[44:47], s74 offen  lds
  s_add_u32 s74, s74, 4096
  s_mov_b32 m0, s75
  s_add_u32 s75, s75, 1024
  buffer_load_dwordx4 v226, s[44:47], s74 offen  lds
  s_add_u32 s74, s74, 4096
  s_mov_b32 m0, s75
  s_add_u32 s75, s75, 1024
  buffer_load_dwordx4 v222, s[44:47], s74 offen  lds
  s_add_u32 s74, s74, 4096
  s_mov_b32 m0, s75
  s_add_u32 s75, s75, 1024
  buffer_load_dwordx4 v226, s[44:47], s74 offen  lds
  s_add_u32 s74, s74, 4096
  s_mov_b32 m0, s75
  s_add_u32 s75, s75, 1024
  buffer_load_dwordx4 v222, s[44:47], s74 offen  lds
  s_add_u32 s74, s74, 4096
  s_mov_b32 m0, s75
  s_add_u32 s75, s75, 1024
  buffer_load_dwordx4 v226, s[44:47], s74 offen  lds
  s_add_u32 s74, s74, 4096
  s_mov_b32 m0, s75
  s_add_u32 s75, s75, 1024
  buffer_load_dwordx4 v222, s[44:47], s74 offen  lds
  s_add_u32 s74, s74, 4096
  s_mov_b32 m0, s75
  s_add_u32 s75, s75, 1024
  buffer_load_dwordx4 v226, s[44:47], s74 offen  lds
  s_add_u32 s74, s74, 4096
  s_branch L_kv_b7_35
L_kv_b0_36:
  s_waitcnt vmcnt(8)
L_kv_b7_35:
  s_barrier
  ds_read_b128 v[16:19], v231 offset:0
  ds_read_b128 v[20:23], v231 offset:16
  ds_read_b128 v[24:27], v231 offset:32
  ds_read_b128 v[28:31], v231 offset:48
  ds_read_b128 v[32:35], v231 offset:64
  ds_read_b128 v[36:39], v231 offset:80
  ds_read_b128 v[40:43], v231 offset:96
  ds_read_b128 v[44:47], v231 offset:112
  ds_read_b128 v[60:63], v231 offset:16640
  ds_read_b128 v[64:67], v231 offset:16656
  ds_read_b128 v[68:71], v231 offset:16672
  ds_read_b128 v[72:75], v231 offset:16688
  ds_read_b128 v[76:79], v231 offset:16704
  ds_read_b128 v[80:83], v231 offset:16720
  ds_read_b128 v[84:87], v231 offset:16736
  s_waitcnt lgkmcnt(8)
  ds_read_b128 v[88:91], v231 offset:16752
  s_load_dwordx2 s[28:29], s[38:39], s70 glc
  ds_read_b32 v237, v227 offset:8
  s_waitcnt vmcnt(0) lgkmcnt(0)
  s_barrier
  s_memrealtime s[0:1]
  s_mov_b32 s61, 0
  s_waitcnt lgkmcnt(0)
  s_cmp_lg_u32 s28, s65
  s_cbranch_scc1 L_kv_nosw_37
  s_sub_u32 s0, s0, s29
  s_cmp_lt_u32 s0, 90
  s_cbranch_scc1 L_kv_nosw_37
  s_mov_b32 s61, 1
  s_mov_b32 s10, s48
  s_mov_b32 s11, s49
  s_mov_b32 m0, s10
  s_add_u32 s10, s10, 8192
  buffer_load_dwordx4 v5, s[40:43], s11 offen sc1 lds
  s_add_u32 s11, s11, 8192
  s_mov_b32 m0, s10
  s_add_u32 s10, s10, 8192
  buffer_load_dwordx4 v5, s[40:43], s11 offen sc1 lds
  s_add_u32 s11, s11, 8192
  s_mov_b32 m0, s10
  s_add_u32 s10, s10, 8192
  buffer_load_dwordx4 v5, s[40:43], s11 offen sc1 lds
  s_add_u32 s11, s11, 8192
  s_mov_b32 m0, s10
  s_add_u32 s10, s10, 8192
  buffer_load_dwordx4 v5, s[40:43], s11 offen sc1 lds
  s_add_u32 s11, s11, 8192
  s_mov_b32 m0, s10
  s_add_u32 s10, s10, 8192
  buffer_load_dwordx4 v5, s[40:43], s11 offen sc1 lds
  s_add_u32 s11, s11, 8192
  s_cmp_ge_u32 s7, 4
  s_cbranch_scc1 L_kv_sw5_38
  s_mov_b32 m0, s10
  s_add_u32 s10, s10, 8192
  buffer_load_dwordx4 v5, s[40:43], s11 offen sc1 lds
  s_add_u32 s11, s11, 8192
L_kv_sw5_38:
L_kv_nosw_37:
  ds_read_b64_tr_b16 v[104:105], v223 offset:0
  ds_read_b64_tr_b16 v[106:107], v223 offset:4096
  ds_read_b64_tr_b16 v[108:109], v229 offset:0
  ds_read_b64_tr_b16 v[110:111], v229 offset:4096
  ds_read_b64_tr_b16 v[112:113], v223 offset:8192
  ds_read_b64_tr_b16 v[114:115], v223 offset:12288
  ds_read_b64_tr_b16 v[116:117], v229 offset:8192
  ds_read_b64_tr_b16 v[118:119], v229 offset:12288
  ds_read_b64_tr_b16 v[120:121], v223 offset:16384
  ds_read_b64_tr_b16 v[122:123], v223 offset:20480
  ds_read_b64_tr_b16 v[124:125], v229 offset:16384
  ds_read_b64_tr_b16 v[126:127], v229 offset:20480
  s_waitcnt lgkmcnt(3)
  ds_read_b64_tr_b16 v[128:129], v223 offset:24576
  ds_read_b64_tr_b16 v[130:131], v223 offset:28672
  ds_read_b64_tr_b16 v[132:133], v229 offset:24576
  ds_read_b64_tr_b16 v[134:135], v229 offset:28672
  ds_read_b64_tr_b16 v[136:137], v223 offset:32768
  ds_read_b64_tr_b16 v[138:139], v223 offset:36864
  ds_read_b64_tr_b16 v[140:141], v229 offset:32768
  ds_read_b64_tr_b16 v[142:143], v229 offset:36864
  ds_read_b64_tr_b16 v[144:145], v223 offset:40960
  ds_read_b64_tr_b16 v[146:147], v223 offset:45056
  ds_read_b64_tr_b16 v[148:149], v229 offset:40960
  ds_read_b64_tr_b16 v[150:151], v229 offset:45056
  s_waitcnt lgkmcnt(3)
  ds_read_b64_tr_b16 v[152:153], v223 offset:49152
  ds_read_b64_tr_b16 v[154:155], v223 offset:53248
  ds_read_b64_tr_b16 v[156:157], v229 offset:49152
  ds_read_b64_tr_b16 v[158:159], v229 offset:53248
  ds_read_b64_tr_b16 v[160:161], v223 offset:57344
  ds_read_b64_tr_b16 v[162:163], v223 offset:61440
  ds_read_b64_tr_b16 v[164:165], v229 offset:57344
  ds_read_b64_tr_b16 v[166:167], v229 offset:61440
  v_mov_b32 v48, v19
  v_mov_b32 v49, v23
  v_mov_b32 v50, v27
  v_mov_b32 v51, 0
  v_mov_b32 v52, v31
  v_mov_b32 v53, v35
  v_mov_b32 v54, v39
  v_mov_b32 v55, 0
  v_mov_b32 v56, v43
  v_mov_b32 v57, v47
  v_mov_b32 v58, 0
  v_mov_b32 v59, 0
  v_mov_b32 v92, v63
  v_mov_b32 v93, v67
  v_mov_b32 v94, v71
  v_mov_b32 v95, 0
  v_mov_b32 v96, v75
  v_mov_b32 v97, v79
  v_mov_b32 v98, v83
  v_mov_b32 v99, 0
  v_mov_b32 v100, v87
  v_mov_b32 v101, v91
  v_mov_b32 v102, 0
  v_mov_b32 v103, 0
  s_cmp_eq_u32 s61, 1
  s_cbranch_scc1 L_kv_swd_39
  s_cmp_eq_u32 s28, s65
  s_cbranch_scc1 L_kv_have_40
  s_mov_b32 s60, 0
L_sg_41:
  s_load_dwordx2 s[28:29], s[38:39], s70 glc
  s_add_u32 s60, s60, 1
  s_cmp_lg_u32 s60, 10
  s_cbranch_scc1 L_snr_43
  s_cmp_lg_u32 s7, 0
  s_cbranch_scc1 L_kv_rq_44
  s_mov_b32 exec_hi, 0
  buffer_store_dwordx4 v[232:235], v5, s[40:43], s73 offen sc1
  s_mov_b64 exec, -1
L_kv_rq_44:
L_snr_43:
  s_cmp_ge_u32 s60, 100000
  s_cbranch_scc1 L_sgd_42
  s_waitcnt lgkmcnt(0)
  s_cmp_lg_u32 s28, s65
  s_cbranch_scc1 L_sg_41
L_sgd_42:
  s_waitcnt lgkmcnt(0)
L_kv_have_40:
L_un_45:
  s_memrealtime s[0:1]
  s_waitcnt lgkmcnt(0)
  s_sub_u32 s0, s0, s29
  s_cmp_lt_u32 s0, 90
  s_cbranch_scc1 L_un_45
  s_mov_b32 s10, s48
  s_mov_b32 s11, s49
  s_mov_b32 m0, s10
  s_add_u32 s10, s10, 8192
  buffer_load_dwordx4 v5, s[40:43], s11 offen sc1 lds
  s_add_u32 s11, s11, 8192
  s_mov_b32 m0, s10
  s_add_u32 s10, s10, 8192
  buffer_load_dwordx4 v5, s[40:43], s11 offen sc1 lds
  s_add_u32 s11, s11, 8192
  s_mov_b32 m0, s10
  s_add_u32 s10, s10, 8192
  buffer_load_dwordx4 v5, s[40:43], s11 offen sc1 lds
  s_add_u32 s11, s11, 8192
  s_mov_b32 m0, s10
  s_add_u32 s10, s10, 8192
  buffer_load_dwordx4 v5, s[40:43], s11 offen sc1 lds
  s_add_u32 s11, s11, 8192
  s_mov_b32 m0, s10
  s_add_u32 s10, s10, 8192
  buffer_load_dwordx4 v5, s[40:43], s11 offen sc1 lds
  s_add_u32 s11, s11, 8192
  s_cmp_ge_u32 s7, 4
  s_cbranch_scc1 L_kv_sw5_46
  s_mov_b32 m0, s10
  s_add_u32 s10, s10, 8192
  buffer_load_dwordx4 v5, s[40:43], s11 offen sc1 lds
  s_add_u32 s11, s11, 8192
L_kv_sw5_46:
L_kv_swd_39:
  s_waitcnt lgkmcnt(0)
  v_readfirstlane_b32 s66, v237
  s_mov_b32 s60, 0
  s_mov_b32 s3, 0
  s_branch L_kv_first_48
L_kv_sweep_47:
  s_mov_b32 s10, s48
  s_mov_b32 s11, s49
  s_mov_b32 m0, s10
  s_add_u32 s10, s10, 8192
  buffer_load_dwordx4 v5, s[40:43], s11 offen sc1 lds
  s_add_u32 s11, s11, 8192
  s_mov_b32 m0, s10
  s_add_u32 s10, s10, 8192
  buffer_load_dwordx4 v5, s[40:43], s11 offen sc1 lds
  s_add_u32 s11, s11, 8192
  s_mov_b32 m0, s10
  s_add_u32 s10, s10, 8192
  buffer_load_dwordx4 v5, s[40:43], s11 offen sc1 lds
  s_add_u32 s11, s11, 8192
  s_mov_b32 m0, s10
  s_add_u32 s10, s10, 8192
  buffer_load_dwordx4 v5, s[40:43], s11 offen sc1 lds
  s_add_u32 s11, s11, 8192
  s_mov_b32 m0, s10
  s_add_u32 s10, s10, 8192
  buffer_load_dwordx4 v5, s[40:43], s11 offen sc1 lds
  s_add_u32 s11, s11, 8192
  s_cmp_ge_u32 s7, 4
  s_cbranch_scc1 L_kv_sw5_49
  s_mov_b32 m0, s10
  s_add_u32 s10, s10, 8192
  buffer_load_dwordx4 v5, s[40:43], s11 offen sc1 lds
  s_add_u32 s11, s11, 8192
L_kv_sw5_49:
L_kv_first_48:
  s_waitcnt vmcnt(0)
  s_barrier
  ds_read_b128 v[168:171], v6 offset:4096
  ds_read_b128 v[172:175], v6 offset:4128
  ds_read_b128 v[176:179], v6 offset:4160
  ds_read_b128 v[180:183], v6 offset:4192
  ds_read_b128 v[184:187], v6 offset:4224
  ds_read_b128 v[188:191], v6 offset:4256
  ds_read_b128 v[192:195], v6 offset:4288
  ds_read_b128 v[196:199], v6 offset:4320
  ds_read_b128 v[200:203], v6 offset:4352
  ds_read_b128 v[204:207], v6 offset:4384
  ds_read_b128 v[208:211], v6 offset:4416
  s_waitcnt lgkmcnt(10)
  v_xor_b32 v224, s67, v171
  v_mov_b32 v171, 0
  s_waitcnt lgkmcnt(9)
  v_bitop3_b32 v224, v224, v175, s67 bitop3:0xf6
  v_mov_b32 v175, 0
  v_mfma_f32_16x16x32_bf16 v[240:243], v[16:19], v[168:171], 0
  v_mfma_f32_16x16x32_bf16 v[244:247], v[60:63], v[168:171], 0
  s_waitcnt lgkmcnt(8)
  v_bitop3_b32 v224, v224, v179, s67 bitop3:0xf6
  v_mov_b32 v179, 0
  v_mfma_f32_16x16x32_bf16 v[240:243], v[20:23], v[172:175], v[240:243]
  v_mfma_f32_16x16x32_bf16 v[244:247], v[64:67], v[172:175], v[244:247]
  s_waitcnt lgkmcnt(7)
  v_bitop3_b32 v224, v224, v183, s67 bitop3:0xf6
  v_mov_b32 v183, 0
  v_mfma_f32_16x16x32_bf16 v[240:243], v[24:27], v[176:179], v[240:243]
  v_mfma_f32_16x16x32_bf16 v[244:247], v[68:71], v[176:179], v[244:247]
  s_waitcnt lgkmcnt(6)
  v_bitop3_b32 v224, v224, v187, s67 bitop3:0xf6
  v_mov_b32 v187, 0
  v_mfma_f32_16x16x32_bf16 v[240:243], v[28:31], v[180:183], v[240:243]
  v_mfma_f32_16x16x32_bf16 v[244:247], v[72:75], v[180:183], v[244:247]
  s_waitcnt lgkmcnt(5)
  v_bitop3_b32 v224, v224, v191, s67 bitop3:0xf6
  v_mov_b32 v191, 0
  v_mfma_f32_16x16x32_bf16 v[240:243], v[32:35], v[184:187], v[240:243]
  v_mfma_f32_16x16x32_bf16 v[244:247], v[76:79], v[184:187], v[244:247]
  s_waitcnt lgkmcnt(4)
  v_bitop3_b32 v224, v224, v195, s67 bitop3:0xf6
  v_mov_b32 v195, 0
  v_mfma_f32_16x16x32_bf16 v[240:243], v[36:39], v[188:191], v[240:243]
  v_mfma_f32_16x16x32_bf16 v[244:247], v[80:83], v[188:191], v[244:247]
  s_waitcnt lgkmcnt(3)
  v_bitop3_b32 v224, v224, v199, s67 bitop3:0xf6
  v_mov_b32 v199, 0
  v_mfma_f32_16x16x32_bf16 v[240:243], v[40:43], v[192:195], v[240:243]
  v_mfma_f32_16x16x32_bf16 v[244:247], v[84:87], v[192:195], v[244:247]
  s_waitcnt lgkmcnt(2)
  v_bitop3_b32 v224, v224, v203, s67 bitop3:0xf6
  v_mov_b32 v203, 0
  v_mfma_f32_16x16x32_bf16 v[240:243], v[44:47], v[196:199], v[240:243]
  v_mfma_f32_16x16x32_bf16 v[244:247], v[88:91], v[196:199], v[244:247]
  s_waitcnt lgkmcnt(1)
  v_bitop3_b32 v224, v224, v207, s67 bitop3:0xf6
  v_mov_b32 v207, 0
  v_mfma_f32_16x16x32_bf16 v[240:243], v[48:51], v[200:203], v[240:243]
  v_mfma_f32_16x16x32_bf16 v[244:247], v[92:95], v[200:203], v[244:247]
  s_waitcnt lgkmcnt(0)
  v_bitop3_b32 v224, v224, v211, s67 bitop3:0xf6
  v_mov_b32 v211, 0
  v_mfma_f32_16x16x32_bf16 v[240:243], v[52:55], v[204:207], v[240:243]
  v_mfma_f32_16x16x32_bf16 v[244:247], v[96:99], v[204:207], v[244:247]
  v_cmp_ne_u32 vcc, 0, v224
  v_add_u32 v225, s3, v227
  v_mfma_f32_16x16x32_bf16 v[240:243], v[56:59], v[208:211], v[240:243]
  v_mfma_f32_16x16x32_bf16 v[244:247], v[100:103], v[208:211], v[244:247]
  s_cmp_eq_u64 vcc, 0
  s_cbranch_scc1 L_kv_ok_50
  ds_write_b32 v225, v221 offset:16
L_kv_ok_50:
  s_cmp_lt_u32 s7, 4
  s_cbranch_scc1 L_kv_nox_51
  s_nop 3
  ds_write_b128 v9, v[240:243] offset:49152
  ds_write_b128 v9, v[244:247] offset:50176
L_kv_nox_51:
  s_waitcnt lgkmcnt(0)
  s_barrier
  ds_read_b32 v224, v225 offset:16
  ds_read_b128 v[168:171], v9 offset:49152
  ds_read_b128 v[172:175], v9 offset:50176
  s_waitcnt lgkmcnt(2)
  v_readfirstlane_b32 s10, v224
  s_nop 0
  s_cmp_eq_u32 s10, 0
  s_cbranch_scc1 L_kv_go_52
  s_waitcnt lgkmcnt(0)
  s_xor_b32 s3, s3, 4
  v_add_u32 v225, s3, v227
  ds_write_b32 v225, v11 offset:16
  s_add_u32 s60, s60, 1
  s_waitcnt lgkmcnt(0)
  s_barrier
  s_cmp_lg_u32 s7, 0
  s_cbranch_scc1 L_kv_rq_53
  s_mov_b32 exec_hi, 0
  buffer_store_dwordx4 v[232:235], v5, s[40:43], s73 offen sc1
  s_mov_b64 exec, -1
L_kv_rq_53:
  s_cmp_lt_u32 s60, 100000
  s_cbranch_scc1 L_kv_sweep_47
L_kv_go_52:
  s_cmp_ge_u32 s7, 4
  s_cbranch_scc1 L_kv_nosm_54
  s_waitcnt lgkmcnt(0)
  v_pk_add_f32 v[168:169], v[168:169], v[240:241]
  v_pk_add_f32 v[170:171], v[170:171], v[242:243]
  v_pk_add_f32 v[172:173], v[172:173], v[244:245]
  v_pk_add_f32 v[174:175], v[174:175], v[246:247]
  v_cvt_pk_bf16_f32 v176, v168, v169
  v_cvt_pk_bf16_f32 v177, v170, v171
  v_cvt_pk_bf16_f32 v178, v172, v173
  v_cvt_pk_bf16_f32 v179, v174, v175
  v_lshlrev_b32 v168, 16, v176
  v_and_b32 v169, 0xffff0000, v176
  v_lshlrev_b32 v170, 16, v177
  v_and_b32 v171, 0xffff0000, v177
  v_lshlrev_b32 v172, 16, v178
  v_and_b32 v173, 0xffff0000, v178
  v_lshlrev_b32 v174, 16, v179
  v_and_b32 v175, 0xffff0000, v179
  v_mul_f32 v168, s54, v168
  v_mul_f32 v169, s54, v169
  v_mul_f32 v170, s54, v170
  v_mul_f32 v171, s54, v171
  v_mul_f32 v172, s54, v172
  v_mul_f32 v173, s54, v173
  v_mul_f32 v174, s54, v174
  v_mul_f32 v175, s54, v175
  v_cvt_pk_bf16_f32 v176, v168, v169
  v_cvt_pk_bf16_f32 v177, v170, v171
  v_cvt_pk_bf16_f32 v178, v172, v173
  v_cvt_pk_bf16_f32 v179, v174, v175
  v_lshlrev_b32 v168, 16, v176
  v_and_b32 v169, 0xffff0000, v176
  v_lshlrev_b32 v170, 16, v177
  v_and_b32 v171, 0xffff0000, v177
  v_lshlrev_b32 v172, 16, v178
  v_and_b32 v173, 0xffff0000, v178
  v_lshlrev_b32 v174, 16, v179
  v_and_b32 v175, 0xffff0000, v179
  v_max3_f32 v248, v168, v169, v170
  v_max3_f32 v180, v171, v172, v173
  v_max3_f32 v248, v248, v174, v175
  v_max_f32 v248, v248, v180
  v_mov_b32 v180, v248
  s_nop 1
  v_permlane16_swap_b32 v248, v180
  s_nop 0
  v_max_f32 v248, v248, v180
  v_mov_b32 v180, v248
  s_nop 1
  v_permlane32_swap_b32 v248, v180
  s_nop 0
  v_max_f32 v248, v248, v180
  v_mul_f32 v180, s55, v248
  v_fma_f32 v168, v168, s55, -v180
  v_fma_f32 v169, v169, s55, -v180
  v_fma_f32 v170, v170, s55, -v180
  v_fma_f32 v171, v171, s55, -v180
  v_fma_f32 v172, v172, s55, -v180
  v_fma_f32 v173, v173, s55, -v180
  v_fma_f32 v174, v174, s55, -v180
  v_fma_f32 v175, v175, s55, -v180
  v_exp_f32 v168, v168
  v_exp_f32 v169, v169
  v_exp_f32 v170, v170
  v_exp_f32 v171, v171
  v_exp_f32 v172, v172
  v_exp_f32 v173, v173
  v_exp_f32 v174, v174
  v_exp_f32 v175, v175
  s_nop 0
  v_cvt_pk_bf16_f32 v252, v168, v169
  v_cvt_pk_bf16_f32 v253, v170, v171
  v_cvt_pk_bf16_f32 v254, v172, v173
  v_cvt_pk_bf16_f32 v255, v174, v175
  buffer_store_dwordx4 v[252:255], v10, s[40:43], s50 offen
  v_pk_add_f32 v[168:169], v[168:169], v[170:171]
  v_pk_add_f32 v[172:173], v[172:173], v[174:175]
  v_pk_add_f32 v[168:169], v[168:169], v[172:173]
  v_add_f32 v249, v168, v169
  v_mov_b32 v180, v249
  s_nop 1
  v_permlane16_swap_b32 v249, v180
  s_nop 0
  v_add_f32 v249, v249, v180
  v_mov_b32 v180, v249
  s_nop 1
  v_permlane32_swap_b32 v249, v180
  s_nop 0
  v_add_f32 v249, v249, v180
  s_mov_b64 exec, 0xffff
  buffer_store_dwordx2 v[248:249], v212, s[40:43], s50 offen offset:1024
  s_mov_b64 exec, -1
L_kv_nosm_54:
  s_cmp_eq_u32 s66, 0
  s_cbranch_scc1 L_kv_same_55
  s_cmp_ge_u32 s7, 4
  s_cbranch_scc1 L_rp_56
  buffer_store_dwordx4 v[252:255], v10, s[40:43], s50 offen sc1
  s_mov_b64 exec, 0xffff
  buffer_store_dwordx2 v[248:249], v212, s[40:43], s50 offen offset:1024 sc1
  s_mov_b64 exec, -1
L_rp_56:
L_kv_same_55:
  s_mov_b32 s60, 0
L_pl_57:
  buffer_load_dwordx4 v[168:171], v5, s[40:43], s51 offen sc1
  buffer_load_dwordx4 v[172:175], v5, s[40:43], s51 offen offset:1152 sc1
  buffer_load_dwordx2 v[176:177], v213, s[40:43], s51 offen offset:1024 sc1
  s_add_u32 s60, s60, 1
  s_cmp_ge_u32 s60, 100000
  s_cbranch_scc1 L_pld_58
  s_waitcnt vmcnt(0)
  v_max3_u32 v224, v168, v169, v170
  v_max_u32 v224, v224, v171
  v_max3_u32 v224, v224, v172, v173
  v_max3_u32 v224, v224, v174, v175
  v_max3_u32 v224, v224, v176, v177
  v_cmp_eq_u32 vcc, -1, v224
  s_cmp_lg_u64 vcc, 0
  s_cbranch_scc1 L_pl_57
L_pld_58:
  s_waitcnt vmcnt(0)
  ds_write_b128 v7, v[168:171] offset:4096
  ds_write_b128 v7, v[172:175] offset:5120
  ds_write_b64 v214, v[176:177] offset:64
  s_waitcnt lgkmcnt(0)
  s_barrier
  s_cmp_lg_u32 s7, 7
  s_cbranch_scc1 L_kv_sig_59
  s_memrealtime s[0:1]
  s_waitcnt lgkmcnt(0)
  v_mov_b32 v221, s0
  buffer_store_dwordx2 v[220:221], v11, s[40:43], s72 offen sc1
L_kv_sig_59:
  ds_read_b128 v[48:51], v217 offset:64
  ds_read_b128 v[52:55], v217 offset:576
  ds_read_b128 v[56:59], v217 offset:1088
  ds_read_b128 v[60:63], v217 offset:1600
  ds_read_b128 v[16:19], v215 offset:4096
  ds_read_b128 v[20:23], v215 offset:6144
  ds_read_b128 v[24:27], v215 offset:8192
  ds_read_b128 v[28:31], v215 offset:10240
  ds_read_b128 v[32:35], v215 offset:12288
  ds_read_b128 v[36:39], v215 offset:14336
  ds_read_b128 v[40:43], v215 offset:16384
  ds_read_b128 v[44:47], v215 offset:18432
  s_waitcnt lgkmcnt(7)
  v_mfma_f32_16x16x32_bf16 v[168:171], v[104:107], v[16:19], 0
  v_max3_f32 v238, v48, v50, v52
  v_max3_f32 v239, v54, v56, v58
  v_mfma_f32_16x16x32_bf16 v[172:175], v[108:111], v[16:19], 0
  v_max3_f32 v238, v238, v60, v62
  v_max_f32 v238, v238, v239
  s_waitcnt lgkmcnt(6)
  v_mfma_f32_16x16x32_bf16 v[176:179], v[112:115], v[20:23], 0
  v_mul_f32 v239, s55, v238
  v_fma_f32 v48, v48, s55, -v239
  v_mfma_f32_16x16x32_bf16 v[180:183], v[116:119], v[20:23], 0
  v_fma_f32 v50, v50, s55, -v239
  v_fma_f32 v52, v52, s55, -v239
  s_waitcnt lgkmcnt(5)
  v_mfma_f32_16x16x32_bf16 v[184:187], v[120:123], v[24:27], 0
  v_fma_f32 v54, v54, s55, -v239
  v_fma_f32 v56, v56, s55, -v239
  v_mfma_f32_16x16x32_bf16 v[188:191], v[124:127], v[24:27], 0
  v_fma_f32 v58, v58, s55, -v239
  v_fma_f32 v60, v60, s55, -v239
  s_waitcnt lgkmcnt(4)
  v_mfma_f32_16x16x32_bf16 v[192:195], v[128:131], v[28:31], 0
  v_fma_f32 v62, v62, s55, -v239
  v_exp_f32 v48, v48
  v_mfma_f32_16x16x32_bf16 v[196:199], v[132:135], v[28:31], 0
  v_exp_f32 v50, v50
  v_exp_f32 v52, v52
  s_waitcnt lgkmcnt(3)
  v_mfma_f32_16x16x32_bf16 v[200:203], v[136:139], v[32:35], 0
  v_exp_f32 v54, v54
  v_exp_f32 v56, v56
  v_mfma_f32_16x16x32_bf16 v[204:207], v[140:143], v[32:35], 0
  v_exp_f32 v58, v58
  v_exp_f32 v60, v60
  s_waitcnt lgkmcnt(2)
  v_mfma_f32_16x16x32_bf16 v[208:211], v[144:147], v[36:39], 0
  v_exp_f32 v62, v62
  v_and_or_b32 v240, v238, s64, v12
  v_mfma_f32_16x16x32_bf16 v[64:67], v[148:151], v[36:39], 0
  v_mul_f32 v239, v48, v49
  v_fmac_f32 v239, v50, v51
  s_waitcnt lgkmcnt(1)
  v_mfma_f32_16x16x32_bf16 v[68:71], v[152:155], v[40:43], 0
  v_fmac_f32 v239, v52, v53
  v_fmac_f32 v239, v54, v55
  v_mfma_f32_16x16x32_bf16 v[72:75], v[156:159], v[40:43], 0
  v_fmac_f32 v239, v56, v57
  v_fmac_f32 v239, v58, v59
  s_waitcnt lgkmcnt(0)
  v_mfma_f32_16x16x32_bf16 v[76:79], v[160:163], v[44:47], 0
  v_fmac_f32 v239, v60, v61
  v_fmac_f32 v239, v62, v63
  v_mfma_f32_16x16x32_bf16 v[80:83], v[164:167], v[44:47], 0
  s_cmp_lg_u32 s6, 0
  s_cbranch_scc1 L_kv_noos_60
  s_cmp_ge_u32 s7, 2
  s_cbranch_scc1 L_kv_noos_60
  v_and_or_b32 v241, v239, s64, v13
  v_mov_b32 v242, v14
  v_mov_b32 v243, v15
  s_mov_b64 exec, 0xffff
  buffer_store_dwordx4 v[240:243], v219, s[40:43], s53 offen sc1
  s_mov_b64 exec, -1
L_kv_noos_60:
  v_pk_mul_f32 v[168:169], v[168:169], v[48:49] op_sel_hi:[1,0]
  v_pk_mul_f32 v[170:171], v[170:171], v[48:49] op_sel_hi:[1,0]
  v_pk_mul_f32 v[172:173], v[172:173], v[48:49] op_sel_hi:[1,0]
  v_pk_mul_f32 v[174:175], v[174:175], v[48:49] op_sel_hi:[1,0]
  v_pk_fma_f32 v[168:169], v[176:177], v[50:51], v[168:169] op_sel_hi:[1,0,1]
  v_pk_fma_f32 v[170:171], v[178:179], v[50:51], v[170:171] op_sel_hi:[1,0,1]
  v_pk_fma_f32 v[172:173], v[180:181], v[50:51], v[172:173] op_sel_hi:[1,0,1]
  v_pk_fma_f32 v[174:175], v[182:183], v[50:51], v[174:175] op_sel_hi:[1,0,1]
  v_pk_fma_f32 v[168:169], v[184:185], v[52:53], v[168:169] op_sel_hi:[1,0,1]
  v_pk_fma_f32 v[170:171], v[186:187], v[52:53], v[170:171] op_sel_hi:[1,0,1]
  v_pk_fma_f32 v[172:173], v[188:189], v[52:53], v[172:173] op_sel_hi:[1,0,1]
  v_pk_fma_f32 v[174:175], v[190:191], v[52:53], v[174:175] op_sel_hi:[1,0,1]
  v_pk_fma_f32 v[168:169], v[192:193], v[54:55], v[168:169] op_sel_hi:[1,0,1]
  v_pk_fma_f32 v[170:171], v[194:195], v[54:55], v[170:171] op_sel_hi:[1,0,1]
  v_pk_fma_f32 v[172:173], v[196:197], v[54:55], v[172:173] op_sel_hi:[1,0,1]
  v_pk_fma_f32 v[174:175], v[198:199], v[54:55], v[174:175] op_sel_hi:[1,0,1]
  v_pk_fma_f32 v[168:169], v[200:201], v[56:57], v[168:169] op_sel_hi:[1,0,1]
  v_pk_fma_f32 v[170:171], v[202:203], v[56:57], v[170:171] op_sel_hi:[1,0,1]
  v_pk_fma_f32 v[172:173], v[204:205], v[56:57], v[172:173] op_sel_hi:[1,0,1]
  v_pk_fma_f32 v[174:175], v[206:207], v[56:57], v[174:175] op_sel_hi:[1,0,1]
  v_pk_fma_f32 v[168:169], v[208:209], v[58:59], v[168:169] op_sel_hi:[1,0,1]
  v_pk_fma_f32 v[170:171], v[210:211], v[58:59], v[170:171] op_sel_hi:[1,0,1]
  v_pk_fma_f32 v[172:173], v[64:65], v[58:59], v[172:173] op_sel_hi:[1,0,1]
  v_pk_fma_f32 v[174:175], v[66:67], v[58:59], v[174:175] op_sel_hi:[1,0,1]
  v_pk_fma_f32 v[168:169], v[68:69], v[60:61], v[168:169] op_sel_hi:[1,0,1]
  v_pk_fma_f32 v[170:171], v[70:71], v[60:61], v[170:171] op_sel_hi:[1,0,1]
  v_pk_fma_f32 v[172:173], v[72:73], v[60:61], v[172:173] op_sel_hi:[1,0,1]
  v_pk_fma_f32 v[174:175], v[74:75], v[60:61], v[174:175] op_sel_hi:[1,0,1]
  v_pk_fma_f32 v[168:169], v[76:77], v[62:63], v[168:169] op_sel_hi:[1,0,1]
  v_pk_fma_f32 v[170:171], v[78:79], v[62:63], v[170:171] op_sel_hi:[1,0,1]
  v_pk_fma_f32 v[172:173], v[80:81], v[62:63], v[172:173] op_sel_hi:[1,0,1]
  v_pk_fma_f32 v[174:175], v[82:83], v[62:63], v[174:175] op_sel_hi:[1,0,1]
  v_and_or_b32 v168, v168, s64, v12
  v_and_or_b32 v169, v169, s64, v13
  v_and_or_b32 v170, v170, s64, v14
  v_and_or_b32 v171, v171, s64, v15
  buffer_store_dwordx4 v[168:171], v218, s[40:43], s52 offen sc1
  v_and_or_b32 v172, v172, s64, v12
  v_and_or_b32 v173, v173, s64, v13
  v_and_or_b32 v174, v174, s64, v14
  v_and_or_b32 v175, v175, s64, v15
  buffer_store_dwordx4 v[172:175], v218, s[40:43], s52 offen offset:64 sc1
  s_barrier
  v_mov_b32 v236, v220
  s_bfe_u32 s10, s9, 0x20002
  s_lshl_b32 s10, s10, 3
  s_add_u32 s10, s10, s8
  s_cmp_ge_u32 s10, 27
  s_cbranch_scc1 L_kv_nofg_61
  s_lshl_b32 s10, s10, 2
  s_add_u32 s10, s10, s6
  s_sleep 40
  s_cmp_lt_u32 s7, 4
  s_cbranch_scc1 L_kv_fglo_62
  s_mov_b32 s44, s30
  s_and_b32 s45, s31, 0xffff
  s_mov_b32 s46, 2211840
  s_mov_b32 s47, 0x00020000
  v_lshrrev_b32 v6, 1, v1
  v_mul_u32_u24 v6, 3456, v6
  v_and_b32 v7, 1, v1
  v_lshl_add_u32 v6, v7, 4, v6
  s_sub_u32 s11, s7, 4
  s_mul_i32 s11, s11, 160
  s_mul_i32 s12, s11, 3456
  s_lshl_b32 s13, s10, 5
  s_add_u32 s12, s12, s13
  s_lshl_b32 s13, s11, 5
  s_add_u32 s13, s13, 24576
  s_mov_b32 m0, s13
  s_add_u32 s13, s13, 1024
  buffer_load_dwordx4 v6, s[44:47], s12 offen  lds
  s_add_u32 s12, s12, 110592
  s_mov_b32 m0, s13
  s_add_u32 s13, s13, 1024
  buffer_load_dwordx4 v6, s[44:47], s12 offen  lds
  s_add_u32 s12, s12, 110592
  s_mov_b32 m0, s13
  s_add_u32 s13, s13, 1024
  buffer_load_dwordx4 v6, s[44:47], s12 offen  lds
  s_add_u32 s12, s12, 110592
  s_mov_b32 m0, s13
  s_add_u32 s13, s13, 1024
  buffer_load_dwordx4 v6, s[44:47], s12 offen  lds
  s_add_u32 s12, s12, 110592
  s_mov_b32 m0, s13
  s_add_u32 s13, s13, 1024
  buffer_load_dwordx4 v6, s[44:47], s12 offen  lds
  s_add_u32 s12, s12, 110592
  s_waitcnt vmcnt(0)
  s_barrier
  s_branch L_fin
L_kv_nofg_61:
  s_branch L_fin
L_kv_fglo_62:
  s_mov_b32 s44, s16
  s_and_b32 s45, s17, 0xffff
  s_mov_b32 s46, 1280
  s_mov_b32 s47, 0x00020000
  v_lshlrev_b32 v8, 3, v1
  s_mul_i32 s11, s7, 320
  buffer_load_dwordx2 v[48:49], v8, s[44:47], s11 offen
  v_mul_u32_u24 v7, 5120, v3
  v_lshl_add_u32 v7, v2, 4, v7
  s_mul_i32 s12, s10, 20480
  s_lshl_b32 s13, s7, 8
  s_add_u32 s12, s12, s13
  v_add_u32 v7, s12, v7
  global_load_dwordx4 v[16:19], v7, s[32:33] offset:0
  global_load_dwordx4 v[20:23], v7, s[32:33] offset:1280
  global_load_dwordx4 v[24:27], v7, s[32:33] offset:2560
  global_load_dwordx4 v[28:31], v7, s[32:33] offset:3840
  s_cmp_lg_u32 s7, 0
  s_cbranch_scc1 L_kv_b4_63
  v_add_u32 v7, 1024, v7
  global_load_dwordx4 v[32:35], v7, s[32:33] offset:0
  global_load_dwordx4 v[36:39], v7, s[32:33] offset:1280
  global_load_dwordx4 v[40:43], v7, s[32:33] offset:2560
  global_load_dwordx4 v[44:47], v7, s[32:33] offset:3840
L_kv_b4_63:
  v_and_b32 v60, 1, v2
  v_cmp_eq_u32 vcc, 1, v60
  v_mov_b32 v60, 0x0000ffff
  v_mov_b32 v61, 0xffff0000
  v_cndmask_b32 v60, v60, v61, vcc
  v_lshrrev_b32 v61, 1, v2
  v_cmp_eq_u32 vcc, 0, v61
  s_nop 1
  v_cndmask_b32 v52, 0, v60, vcc
  v_cmp_eq_u32 vcc, 1, v61
  s_nop 1
  v_cndmask_b32 v53, 0, v60, vcc
  v_cmp_eq_u32 vcc, 2, v61
  s_nop 1
  v_cndmask_b32 v54, 0, v60, vcc
  v_cmp_eq_u32 vcc, 3, v61
  s_nop 1
  v_cndmask_b32 v55, 0, v60, vcc
  v_lshrrev_b32 v8, 2, v2
  v_lshl_add_u32 v8, v3, 3, v8
  v_lshlrev_b32 v8, 5, v8
  v_and_b32 v9, 3, v2
  v_lshl_add_u32 v8, v9, 3, v8
  s_waitcnt vmcnt(0)
  s_barrier
  ds_read_b64_tr_b16 v[80:81], v8 offset:24576
  ds_read_b64_tr_b16 v[82:83], v8 offset:24704
  ds_read_b64_tr_b16 v[84:85], v8 offset:25600
  ds_read_b64_tr_b16 v[86:87], v8 offset:25728
  ds_read_b64_tr_b16 v[88:89], v8 offset:26624
  ds_read_b64_tr_b16 v[90:91], v8 offset:26752
  ds_read_b64_tr_b16 v[92:93], v8 offset:27648
  ds_read_b64_tr_b16 v[94:95], v8 offset:27776
  s_waitcnt lgkmcnt(0)
  ds_read_b64_tr_b16 v[96:97], v8 offset:28672
  ds_read_b64_tr_b16 v[98:99], v8 offset:28800
  ds_read_b64_tr_b16 v[100:101], v8 offset:29696
  ds_read_b64_tr_b16 v[102:103], v8 offset:29824
  ds_read_b64_tr_b16 v[104:105], v8 offset:30720
  ds_read_b64_tr_b16 v[106:107], v8 offset:30848
  ds_read_b64_tr_b16 v[108:109], v8 offset:31744
  ds_read_b64_tr_b16 v[110:111], v8 offset:31872
  s_waitcnt lgkmcnt(0)
  ds_read_b64_tr_b16 v[112:113], v8 offset:32768
  ds_read_b64_tr_b16 v[114:115], v8 offset:32896
  ds_read_b64_tr_b16 v[116:117], v8 offset:33792
  ds_read_b64_tr_b16 v[118:119], v8 offset:33920
  ds_read_b64_tr_b16 v[120:121], v8 offset:34816
  ds_read_b64_tr_b16 v[122:123], v8 offset:34944
  ds_read_b64_tr_b16 v[124:125], v8 offset:35840
  ds_read_b64_tr_b16 v[126:127], v8 offset:35968
  s_waitcnt lgkmcnt(0)
  ds_read_b64_tr_b16 v[128:129], v8 offset:36864
  ds_read_b64_tr_b16 v[130:131], v8 offset:36992
  ds_read_b64_tr_b16 v[132:133], v8 offset:37888
  ds_read_b64_tr_b16 v[134:135], v8 offset:38016
  ds_read_b64_tr_b16 v[136:137], v8 offset:38912
  ds_read_b64_tr_b16 v[138:139], v8 offset:39040
  ds_read_b64_tr_b16 v[140:141], v8 offset:39936
  ds_read_b64_tr_b16 v[142:143], v8 offset:40064
  s_waitcnt lgkmcnt(0)
  ds_read_b64_tr_b16 v[144:145], v8 offset:40960
  ds_read_b64_tr_b16 v[146:147], v8 offset:41088
  ds_read_b64_tr_b16 v[148:149], v8 offset:41984
  ds_read_b64_tr_b16 v[150:151], v8 offset:42112
  ds_read_b64_tr_b16 v[152:153], v8 offset:43008
  ds_read_b64_tr_b16 v[154:155], v8 offset:43136
  ds_read_b64_tr_b16 v[156:157], v8 offset:44032
  ds_read_b64_tr_b16 v[158:159], v8 offset:44160
  s_waitcnt lgkmcnt(0)
  s_mul_i32 s12, s7, 640
  s_add_u32 s12, s12, 3227648
  s_add_u32 s13, s12, 5120
  s_add_u32 s14, s12, 10240
  s_add_u32 s15, s12, 15360
  v_lshlrev_b32 v56, 16, v48
  v_and_b32 v57, 0xffff0000, v48
  v_lshlrev_b32 v58, 16, v49
  v_and_b32 v59, 0xffff0000, v49
  v_lshlrev_b32 v8, 3, v1
  s_mul_i32 s11, s7, 320
  v_add_u32 v9, s11, v8
  s_mul_i32 s11, s7, 1280
  v_add_u32 v10, s11, v8
  v_add_u32 v228, s11, v4
  v_lshl_add_u32 v229, v3, 4, s11
  v_lshrrev_b32 v230, 1, v2
  v_mul_u32_u24 v230, 7168, v230
  v_and_b32 v231, 1, v2
  v_lshl_add_u32 v230, v231, 5, v230
  v_lshl_add_u32 v230, v3, 4, v230
  s_mul_i32 s52, s7, 57344
  s_lshl_b32 s53, s10, 6
  s_add_u32 s52, s52, s53
  s_add_u32 s52, s52, 3248128
  s_add_u32 s53, s52, 229376
  v_lshlrev_b32 v231, 4, v3
  v_mov_b32 v244, 0x3f803f80
  v_mov_b32 v245, 0x3f803f80
  v_mov_b32 v246, 0x3f803f80
  v_mov_b32 v247, 0x3f803f80
  s_nop 1
  v_mfma_f32_16x16x32_bf16 v[76:79], v[80:83], v[244:247], 0
  v_mfma_f32_16x16x32_bf16 v[76:79], v[84:87], v[244:247], v[76:79]
  v_mfma_f32_16x16x32_bf16 v[76:79], v[88:91], v[244:247], v[76:79]
  v_mfma_f32_16x16x32_bf16 v[76:79], v[92:95], v[244:247], v[76:79]
  v_mfma_f32_16x16x32_bf16 v[76:79], v[96:99], v[244:247], v[76:79]
  v_mfma_f32_16x16x32_bf16 v[76:79], v[100:103], v[244:247], v[76:79]
  v_mfma_f32_16x16x32_bf16 v[76:79], v[104:107], v[244:247], v[76:79]
  v_mfma_f32_16x16x32_bf16 v[76:79], v[108:111], v[244:247], v[76:79]
  v_mfma_f32_16x16x32_bf16 v[76:79], v[112:115], v[244:247], v[76:79]
  v_mfma_f32_16x16x32_bf16 v[76:79], v[116:119], v[244:247], v[76:79]
  v_mfma_f32_16x16x32_bf16 v[76:79], v[120:123], v[244:247], v[76:79]
  v_mfma_f32_16x16x32_bf16 v[76:79], v[124:127], v[244:247], v[76:79]
  v_mfma_f32_16x16x32_bf16 v[76:79], v[128:131], v[244:247], v[76:79]
  v_mfma_f32_16x16x32_bf16 v[76:79], v[132:135], v[244:247], v[76:79]
  v_mfma_f32_16x16x32_bf16 v[76:79], v[136:139], v[244:247], v[76:79]
  v_mfma_f32_16x16x32_bf16 v[76:79], v[140:143], v[244:247], v[76:79]
  v_mfma_f32_16x16x32_bf16 v[76:79], v[144:147], v[244:247], v[76:79]
  v_mfma_f32_16x16x32_bf16 v[76:79], v[148:151], v[244:247], v[76:79]
  v_mfma_f32_16x16x32_bf16 v[76:79], v[152:155], v[244:247], v[76:79]
  v_mfma_f32_16x16x32_bf16 v[76:79], v[156:159], v[244:247], v[76:79]
  s_lshl_b32 s70, s4, 7
  s_add_u32 s70, s70, 3588096
  s_lshl_b32 s71, s4, 7
  s_add_u32 s71, s71, 3604480
  s_mov_b32 s60, 0
L_sg_64:
  s_load_dwordx2 s[28:29], s[38:39], s70 glc
  s_add_u32 s60, s60, 1
  s_cmp_ge_u32 s60, 100000
  s_cbranch_scc1 L_sgd_65
  s_waitcnt lgkmcnt(0)
  s_cmp_lg_u32 s28, s65
  s_cbranch_scc1 L_sg_64
L_un_66:
  s_memrealtime s[0:1]
  s_waitcnt lgkmcnt(0)
  s_sub_u32 s0, s0, s29
  s_cmp_lt_u32 s0, 42
  s_cbranch_scc1 L_un_66
L_sgd_65:
  s_waitcnt lgkmcnt(0)
  s_mov_b32 exec_hi, 0xff
  s_mov_b32 s60, 0
L_ps_67:
  buffer_load_dwordx4 v[160:163], v5, s[40:43], s12 offen offset:0 sc1
  buffer_load_dwordx4 v[164:167], v5, s[40:43], s12 offen offset:2560 sc1
  buffer_load_dwordx4 v[168:171], v5, s[40:43], s13 offen offset:0 sc1
  buffer_load_dwordx4 v[172:175], v5, s[40:43], s13 offen offset:2560 sc1
  buffer_load_dwordx4 v[176:179], v5, s[40:43], s14 offen offset:0 sc1
  buffer_load_dwordx4 v[180:183], v5, s[40:43], s14 offen offset:2560 sc1
  buffer_load_dwordx4 v[184:187], v5, s[40:43], s15 offen offset:0 sc1
  buffer_load_dwordx4 v[188:191], v5, s[40:43], s15 offen offset:2560 sc1
  s_add_u32 s60, s60, 1
  s_waitcnt vmcnt(7)
  v_xor_b32 v60, v160, v12
  v_bitop3_b32 v60, v60, v161, v13 bitop3:0xf6
  v_bitop3_b32 v60, v60, v162, v14 bitop3:0xf6
  v_bitop3_b32 v60, v60, v163, v15 bitop3:0xf6
  s_waitcnt vmcnt(6)
  v_bitop3_b32 v60, v60, v164, v12 bitop3:0xf6
  v_bitop3_b32 v60, v60, v165, v13 bitop3:0xf6
  v_bitop3_b32 v60, v60, v166, v14 bitop3:0xf6
  v_bitop3_b32 v60, v60, v167, v15 bitop3:0xf6
  v_pk_add_f32 v[192:193], v[160:161], v[164:165]
  v_pk_add_f32 v[194:195], v[162:163], v[166:167]
  s_waitcnt vmcnt(5)
  v_bitop3_b32 v60, v60, v168, v12 bitop3:0xf6
  v_bitop3_b32 v60, v60, v169, v13 bitop3:0xf6
  v_bitop3_b32 v60, v60, v170, v14 bitop3:0xf6
  v_bitop3_b32 v60, v60, v171, v15 bitop3:0xf6
  v_pk_add_f32 v[192:193], v[192:193], v[168:169]
  v_pk_add_f32 v[194:195], v[194:195], v[170:171]
  s_waitcnt vmcnt(4)
  v_bitop3_b32 v60, v60, v172, v12 bitop3:0xf6
  v_bitop3_b32 v60, v60, v173, v13 bitop3:0xf6
  v_bitop3_b32 v60, v60, v174, v14 bitop3:0xf6
  v_bitop3_b32 v60, v60, v175, v15 bitop3:0xf6
  v_pk_add_f32 v[192:193], v[192:193], v[172:173]
  v_pk_add_f32 v[194:195], v[194:195], v[174:175]
  s_waitcnt vmcnt(3)
  v_bitop3_b32 v60, v60, v176, v12 bitop3:0xf6
  v_bitop3_b32 v60, v60, v177, v13 bitop3:0xf6
  v_bitop3_b32 v60, v60, v178, v14 bitop3:0xf6
  v_bitop3_b32 v60, v60, v179, v15 bitop3:0xf6
  v_pk_add_f32 v[192:193], v[192:193], v[176:177]
  v_pk_add_f32 v[194:195], v[194:195], v[178:179]
  s_waitcnt vmcnt(2)
  v_bitop3_b32 v60, v60, v180, v12 bitop3:0xf6
  v_bitop3_b32 v60, v60, v181, v13 bitop3:0xf6
  v_bitop3_b32 v60, v60, v182, v14 bitop3:0xf6
  v_bitop3_b32 v60, v60, v183, v15 bitop3:0xf6
  v_pk_add_f32 v[192:193], v[192:193], v[180:181]
  v_pk_add_f32 v[194:195], v[194:195], v[182:183]
  s_waitcnt vmcnt(1)
  v_bitop3_b32 v60, v60, v184, v12 bitop3:0xf6
  v_bitop3_b32 v60, v60, v185, v13 bitop3:0xf6
  v_bitop3_b32 v60, v60, v186, v14 bitop3:0xf6
  v_bitop3_b32 v60, v60, v187, v15 bitop3:0xf6
  v_pk_add_f32 v[192:193], v[192:193], v[184:185]
  v_pk_add_f32 v[194:195], v[194:195], v[186:187]
  s_waitcnt vmcnt(0)
  v_bitop3_b32 v60, v60, v188, v12 bitop3:0xf6
  v_bitop3_b32 v60, v60, v189, v13 bitop3:0xf6
  v_bitop3_b32 v60, v60, v190, v14 bitop3:0xf6
  v_bitop3_b32 v60, v60, v191, v15 bitop3:0xf6
  v_pk_add_f32 v[192:193], v[192:193], v[188:189]
  v_pk_add_f32 v[194:195], v[194:195], v[190:191]
  v_and_b32 v60, 0xff, v60
  v_cmp_ne_u32 vcc, 0, v60
  s_cmp_lt_u32 s60, 100000
  s_cselect_b64 vcc, vcc, 0
  s_cmp_lg_u64 vcc, 0
  s_cbranch_scc1 L_ps_67
  v_cvt_pk_bf16_f32 v60, v192, v193
  v_cvt_pk_bf16_f32 v61, v194, v195
  v_lshlrev_b32 v160, 16, v60
  v_and_b32 v161, 0xffff0000, v60
  v_lshlrev_b32 v162, 16, v61
  v_and_b32 v163, 0xffff0000, v61
  v_pk_add_f32 v[160:161], v[160:161], v[56:57]
  v_pk_add_f32 v[162:163], v[162:163], v[58:59]
  v_cvt_pk_bf16_f32 v60, v160, v161
  v_cvt_pk_bf16_f32 v61, v162, v163
  ds_write_b64 v9, v[60:61] offset:50176
  s_mov_b64 exec, -1
  s_waitcnt lgkmcnt(0)
  s_barrier
  ds_read_b64 v[70:71], v8 offset:50176
  ds_read_b64 v[72:73], v8 offset:50688
  ds_read_b32 v74, v4 offset:51200
  ds_read_b128 v[160:163], v231 offset:50176
  ds_read_b128 v[164:167], v231 offset:50240
  ds_read_b128 v[168:171], v231 offset:50304
  ds_read_b128 v[172:175], v231 offset:50368
  ds_read_b128 v[176:179], v231 offset:50432
  ds_read_b128 v[180:183], v231 offset:50496
  ds_read_b128 v[184:187], v231 offset:50560
  ds_read_b128 v[188:191], v231 offset:50624
  ds_read_b128 v[192:195], v231 offset:50688
  ds_read_b128 v[196:199], v231 offset:50752
  ds_read_b128 v[200:203], v231 offset:50816
  ds_read_b128 v[204:207], v231 offset:50880
  s_waitcnt lgkmcnt(11)
  v_mfma_f32_16x16x32_bf16 v[56:59], v[80:83], v[160:163], 0
  v_lshlrev_b32 v60, 16, v70
  v_and_b32 v61, 0xffff0000, v70
  v_lshlrev_b32 v62, 16, v71
  v_and_b32 v63, 0xffff0000, v71
  ds_read_b128 v[160:163], v231 offset:50944
  s_waitcnt lgkmcnt(11)
  v_mfma_f32_16x16x32_bf16 v[56:59], v[84:87], v[164:167], v[56:59]
  v_lshlrev_b32 v64, 16, v72
  v_and_b32 v65, 0xffff0000, v72
  v_lshlrev_b32 v66, 16, v73
  v_and_b32 v67, 0xffff0000, v73
  ds_read_b128 v[164:167], v231 offset:51008
  s_waitcnt lgkmcnt(11)
  v_mfma_f32_16x16x32_bf16 v[56:59], v[88:91], v[168:171], v[56:59]
  v_lshlrev_b32 v68, 16, v74
  v_and_b32 v69, 0xffff0000, v74
  v_readfirstlane_b32 s62, v60
  s_nop 1
  ds_read_b128 v[168:171], v231 offset:51072
  s_waitcnt lgkmcnt(11)
  v_mfma_f32_16x16x32_bf16 v[56:59], v[92:95], v[172:175], v[56:59]
  v_mov_b32 v74, s62
  v_pk_add_f32 v[250:251], v[60:61], v[74:75] op_sel_hi:[1,0] neg_lo:[0,1] neg_hi:[0,1]
  v_pk_mul_f32 v[72:73], v[250:251], v[250:251]
  v_mov_b32 v70, v250
  ds_read_b128 v[172:175], v231 offset:51136
  s_waitcnt lgkmcnt(11)
  v_mfma_f32_16x16x32_bf16 v[56:59], v[96:99], v[176:179], v[56:59]
  v_mov_b32 v71, v251
  v_pk_add_f32 v[250:251], v[62:63], v[74:75] op_sel_hi:[1,0] neg_lo:[0,1] neg_hi:[0,1]
  v_pk_fma_f32 v[72:73], v[250:251], v[250:251], v[72:73]
  v_pk_add_f32 v[70:71], v[70:71], v[250:251]
  ds_read_b128 v[176:179], v231 offset:51200
  s_waitcnt lgkmcnt(11)
  v_mfma_f32_16x16x32_bf16 v[56:59], v[100:103], v[180:183], v[56:59]
  v_pk_add_f32 v[250:251], v[64:65], v[74:75] op_sel_hi:[1,0] neg_lo:[0,1] neg_hi:[0,1]
  v_pk_fma_f32 v[72:73], v[250:251], v[250:251], v[72:73]
  v_pk_add_f32 v[70:71], v[70:71], v[250:251]
  v_pk_add_f32 v[250:251], v[66:67], v[74:75] op_sel_hi:[1,0] neg_lo:[0,1] neg_hi:[0,1]
  ds_read_b128 v[180:183], v231 offset:51264
  s_waitcnt lgkmcnt(11)
  v_mfma_f32_16x16x32_bf16 v[56:59], v[104:107], v[184:187], v[56:59]
  v_pk_fma_f32 v[72:73], v[250:251], v[250:251], v[72:73]
  v_pk_add_f32 v[70:71], v[70:71], v[250:251]
  v_pk_add_f32 v[250:251], v[68:69], v[74:75] op_sel_hi:[1,0] neg_lo:[0,1] neg_hi:[0,1]
  v_pk_fma_f32 v[72:73], v[250:251], v[250:251], v[72:73]
  ds_read_b128 v[184:187], v231 offset:51328
  s_waitcnt lgkmcnt(11)
  v_mfma_f32_16x16x32_bf16 v[56:59], v[108:111], v[188:191], v[56:59]
  v_pk_add_f32 v[70:71], v[70:71], v[250:251]
  v_add_f32 v72, v72, v73
  v_add_f32 v70, v70, v71
  v_mov_b32 v75, 0x3acccccd
  ds_read_b128 v[188:191], v231 offset:51392
  s_waitcnt lgkmcnt(11)
  v_mfma_f32_16x16x32_bf16 v[56:59], v[112:115], v[192:195], v[56:59]
  v_add_f32_dpp v72, v72, v72 row_shr:1 row_mask:0xf bank_mask:0xf bound_ctrl:0
  v_add_f32_dpp v70, v70, v70 row_shr:1 row_mask:0xf bank_mask:0xf bound_ctrl:0
  s_nop 0
  v_add_f32_dpp v72, v72, v72 row_shr:2 row_mask:0xf bank_mask:0xf bound_ctrl:0
  s_waitcnt lgkmcnt(10)
  v_mfma_f32_16x16x32_bf16 v[56:59], v[116:119], v[196:199], v[56:59]
  v_add_f32_dpp v70, v70, v70 row_shr:2 row_mask:0xf bank_mask:0xf bound_ctrl:0
  s_nop 0
  v_add_f32_dpp v72, v72, v72 row_shr:4 row_mask:0xf bank_mask:0xf bound_ctrl:0
  v_add_f32_dpp v70, v70, v70 row_shr:4 row_mask:0xf bank_mask:0xf bound_ctrl:0
  s_waitcnt lgkmcnt(9)
  v_mfma_f32_16x16x32_bf16 v[56:59], v[120:123], v[200:203], v[56:59]
  s_nop 0
  v_add_f32_dpp v72, v72, v72 row_shr:8 row_mask:0xf bank_mask:0xf bound_ctrl:0
  v_add_f32_dpp v70, v70, v70 row_shr:8 row_mask:0xf bank_mask:0xf bound_ctrl:0
  s_nop 0
  s_waitcnt lgkmcnt(8)
  v_mfma_f32_16x16x32_bf16 v[56:59], v[124:127], v[204:207], v[56:59]
  v_add_f32_dpp v72, v72, v72 row_bcast:15 row_mask:0xa bank_mask:0xf
  v_add_f32_dpp v70, v70, v70 row_bcast:15 row_mask:0xa bank_mask:0xf
  s_nop 0
  v_add_f32_dpp v72, v72, v72 row_bcast:31 row_mask:0xc bank_mask:0xf
  s_waitcnt lgkmcnt(7)
  v_mfma_f32_16x16x32_bf16 v[56:59], v[128:131], v[160:163], v[56:59]
  v_add_f32_dpp v70, v70, v70 row_bcast:31 row_mask:0xc bank_mask:0xf
  s_nop 0
  v_readlane_b32 s63, v72, 63
  v_readlane_b32 s62, v70, 63
  s_waitcnt lgkmcnt(6)
  v_mfma_f32_16x16x32_bf16 v[56:59], v[132:135], v[164:167], v[56:59]
  s_nop 0
  v_mul_f32 v72, s63, v75
  v_mul_f32 v70, s62, v75
  v_fma_f32 v72, -v70, v70, v72
  s_waitcnt lgkmcnt(5)
  v_mfma_f32_16x16x32_bf16 v[56:59], v[136:139], v[168:171], v[56:59]
  v_add_f32 v74, v74, v70
  v_max_f32 v72, 0, v72
  v_cvt_pk_bf16_f32 v73, v74, v72
  v_lshlrev_b32 v74, 16, v73
  s_waitcnt lgkmcnt(4)
  v_mfma_f32_16x16x32_bf16 v[56:59], v[140:143], v[172:175], v[56:59]
  v_and_b32 v72, 0xffff0000, v73
  v_add_f32 v72, 0x3727c5ac, v72
  v_cvt_pk_bf16_f32 v72, v72, v72
  v_and_b32 v72, 0xffff0000, v72
  s_waitcnt lgkmcnt(3)
  v_mfma_f32_16x16x32_bf16 v[56:59], v[144:147], v[176:179], v[56:59]
  v_sqrt_f32 v72, v72
  s_nop 0
  v_cvt_pk_bf16_f32 v72, v72, v72
  v_and_b32 v72, 0xffff0000, v72
  s_waitcnt lgkmcnt(2)
  v_mfma_f32_16x16x32_bf16 v[56:59], v[148:151], v[180:183], v[56:59]
  v_rcp_f32 v72, v72
  s_waitcnt lgkmcnt(1)
  v_mfma_f32_16x16x32_bf16 v[56:59], v[152:155], v[184:187], v[56:59]
  s_waitcnt lgkmcnt(0)
  v_mfma_f32_16x16x32_bf16 v[56:59], v[156:159], v[188:191], v[56:59]
  s_cmp_lg_u32 s7, 1
  s_cbranch_scc1 L_kv_s4_68
  s_memrealtime s[0:1]
  s_waitcnt lgkmcnt(0)
  v_mov_b32 v237, s0
  buffer_store_dwordx2 v[236:237], v11, s[40:43], s71 offen sc1
L_kv_s4_68:
  s_nop 5
  v_fma_f32 v56, -v74, v76, v56
  v_fma_f32 v57, -v74, v77, v57
  v_fma_f32 v58, -v74, v78, v58
  v_fma_f32 v59, -v74, v79, v59
  v_mul_f32 v56, v56, v72
  v_mul_f32 v57, v57, v72
  v_mul_f32 v58, v58, v72
  v_mul_f32 v59, v59, v72
  v_max_f32 v56, 0, v56
  v_max_f32 v57, 0, v57
  v_max_f32 v58, 0, v58
  v_max_f32 v59, 0, v59
  v_cvt_pk_bf16_f32 v240, v56, v56
  v_cvt_pk_bf16_f32 v241, v57, v57
  v_cvt_pk_bf16_f32 v242, v58, v58
  v_cvt_pk_bf16_f32 v243, v59, v59
  v_and_b32 v80, v240, v52
  v_and_b32 v81, v240, v53
  v_and_b32 v82, v240, v54
  v_and_b32 v83, v240, v55
  v_and_b32 v84, v241, v52
  v_and_b32 v85, v241, v53
  v_and_b32 v86, v241, v54
  v_and_b32 v87, v241, v55
  v_and_b32 v88, v242, v52
  v_and_b32 v89, v242, v53
  v_and_b32 v90, v242, v54
  v_and_b32 v91, v242, v55
  v_and_b32 v92, v243, v52
  v_and_b32 v93, v243, v53
  v_and_b32 v94, v243, v54
  v_and_b32 v95, v243, v55
  v_mfma_f32_16x16x32_bf16 v[64:67], v[80:83], v[16:19], 0
  v_mfma_f32_16x16x32_bf16 v[64:67], v[84:87], v[20:23], v[64:67]
  v_mfma_f32_16x16x32_bf16 v[64:67], v[88:91], v[24:27], v[64:67]
  v_mfma_f32_16x16x32_bf16 v[64:67], v[92:95], v[28:31], v[64:67]
  s_cmp_lg_u32 s7, 0
  s_cbranch_scc1 L_kv_b5_69
  v_mfma_f32_16x16x32_bf16 v[68:71], v[80:83], v[32:35], 0
  v_mfma_f32_16x16x32_bf16 v[68:71], v[84:87], v[36:39], v[68:71]
  v_mfma_f32_16x16x32_bf16 v[68:71], v[88:91], v[40:43], v[68:71]
  v_mfma_f32_16x16x32_bf16 v[68:71], v[92:95], v[44:47], v[68:71]
  s_nop 3
  v_and_or_b32 v64, v64, s64, v12
  v_and_or_b32 v65, v65, s64, v13
  v_and_or_b32 v66, v66, s64, v14
  v_and_or_b32 v67, v67, s64, v15
  s_mov_b32 exec_hi, 0
  buffer_store_dwordx4 v[64:67], v230, s[40:43], s52 offen sc1
  v_and_or_b32 v68, v68, s64, v12
  v_and_or_b32 v69, v69, s64, v13
  v_and_or_b32 v70, v70, s64, v14
  v_and_or_b32 v71, v71, s64, v15
  buffer_store_dwordx4 v[68:71], v230, s[40:43], s53 offen sc1
  s_mov_b64 exec, -1
  s_branch L_fin
L_kv_b5_69:
  s_nop 5
  v_and_or_b32 v64, v64, s64, v12
  v_and_or_b32 v65, v65, s64, v13
  v_and_or_b32 v66, v66, s64, v14
  v_and_or_b32 v67, v67, s64, v15
  s_mov_b32 exec_hi, 0
  buffer_store_dwordx4 v[64:67], v230, s[40:43], s52 offen sc1
  s_mov_b64 exec, -1
L_fin:
L_end:
  s_endpgm
L_codeend:
.section .rodata,"a"
.p2align 6
.amdhsa_kernel sequential_preLN__compressed_kv_cla__dense_activation_relu__decode_kernel
  .amdhsa_next_free_vgpr 256
  .amdhsa_next_free_sgpr 100
  .amdhsa_accum_offset 256
  .amdhsa_group_segment_fixed_size 0
  .amdhsa_kernarg_size 96
  .amdhsa_user_sgpr_count 2
  .amdhsa_user_sgpr_kernarg_segment_ptr 1
  .amdhsa_system_sgpr_workgroup_id_x 1
.end_amdhsa_kernel
```
